```python
import torch

def _softmax(x, axis=-1):
    return torch.softmax(x, dim=axis)
def _gelu(x):
    return torch.nn.functional.gelu(x, approximate="tanh")
def _silu(x):
    return torch.nn.functional.silu(x)
def _sigmoid(x):
    return torch.sigmoid(x)
def _layernorm(x, axis=-1, eps=1e-5):
    m = x.mean(dim=axis, keepdim=True)
    v = x.var(dim=axis, keepdim=True, unbiased=False)
    return (x - m) / torch.sqrt(v + eps)
def _scatter_add(tgt, idx, src, axis=0):
    return tgt.clone().index_add_(axis, idx, src)
def _segment_sum(src, seg, n):
    out = torch.zeros((n,) + src.shape[1:], dtype=src.dtype)
    return out.index_add_(0, seg, src)
def _pad(x, pw):
    flat = tuple(v for pair in reversed(pw) for v in pair)
    return torch.nn.functional.pad(x, flat)

kernel_name = 'recurrent_scan__gqa_block_cached__geglu_ffn__decode'

def setup_inputs():

    _w = (lambda a: (lambda t: t.to(torch.bfloat16) if t.is_floating_point() else t)(torch.as_tensor(a)))
    def _A_setup():
        B, Sq, D = 1, 1, 576
        Hq, Hkv, Sk, Dh = 32, 16, 65536, 128
        assert Hq % Hkv == 0, (Hq, Hkv)
        return {
            "x": _w((lambda *s: torch.randn(*s, dtype=torch.bfloat16) * 0.05)(B, Sq, D)),
            "k_cache": _w((lambda *s: torch.randn(*s, dtype=torch.bfloat16) * 1.6)(B, Hkv, Sk, Dh)),
            "v_cache": _w((lambda *s: torch.randn(*s, dtype=torch.bfloat16) * 0.2)(B, Hkv, Sk, Dh)),
            "wq": _w((lambda *s: torch.randn(*s, dtype=torch.bfloat16) * 1.6)(D, Hq * Dh) * (D ** -0.5)),
            "wo": _w((lambda *s: torch.randn(*s, dtype=torch.bfloat16) * 0.2)(Hq * Dh, D) * ((Hq * Dh) ** -0.5)),
        }
    _A_in = _A_setup()

    def _B_setup():
        B, S, D, F = 1, 1, 576, 4608
        return {
            "x": _w((lambda *s: torch.randn(*s, dtype=torch.bfloat16) * 0.05)(B, S, D)),
            "w_gate": _w((lambda *s: torch.randn(*s, dtype=torch.bfloat16) * 0.1)(D, F)),
            "w_up": _w((lambda *s: torch.randn(*s, dtype=torch.bfloat16) * 0.1)(D, F)),
            "w_down": _w((lambda *s: torch.randn(*s, dtype=torch.bfloat16) * 0.1)(F, D)),
        }
    _B_in = _B_setup()

    return {
        "A_x": _A_in["x"],
        "A_k_cache": _A_in["k_cache"],
        "A_v_cache": _A_in["v_cache"],
        "A_wq": _A_in["wq"],
        "A_wo": _A_in["wo"],
        "B_x": _B_in["x"],
        "B_w_gate": _B_in["w_gate"],
        "B_w_up": _B_in["w_up"],
        "B_w_down": _B_in["w_down"],
    }

def reference(A_x, A_k_cache, A_v_cache, A_wq, A_wo, B_x, B_w_gate, B_w_up, B_w_down):
    def _A_ref(x, k_cache, v_cache, wq, wo):
        B, Sq, D = x.shape
        Hq, Dh = 32, 128
        Hkv = k_cache.shape[1]
        rep = Hq // Hkv
        q = (lambda x, *d: x.permute(*d))((x @ wq).reshape(B, Sq, Hq, Dh), 0, 2, 1, 3)
        k = (lambda x, n, axis: torch.repeat_interleave(x, n, dim=axis))(k_cache, rep, axis=1)
        v = (lambda x, n, axis: torch.repeat_interleave(x, n, dim=axis))(v_cache, rep, axis=1)
        scores = torch.einsum("bhqd,bhkd->bhqk", q, k) * (Dh ** -0.5)
        p = _softmax(scores, axis=-1)
        o = torch.einsum("bhqk,bhkd->bhqd", p, v)
        return (lambda x, *d: x.permute(*d))(o, 0, 2, 1, 3).reshape(B, Sq, Hq * Dh) @ wo

    def _B_ref(x, w_gate, w_up, w_down):
        return (_gelu(x @ w_gate) * (x @ w_up)) @ w_down

    x = A_x
    xn = _layernorm(x, axis=-1)
    s = _A_ref(xn, A_k_cache, A_v_cache, A_wq, A_wo)
    g = _silu(_B_ref(xn, B_w_gate, B_w_up, B_w_down))
    return x + s * g
```

```asm
; @launch kernel=pre_kernel grid=(256,1,1) block=(576,1,1) lds=86016
; @launch kernel=recurrent_scan__gqa_block_cached__geglu_ffn__decode_kernel grid=(256,1,1) block=(512,1,1) lds=86016
.amdgcn_target "amdgcn-amd-amdhsa--gfx950"
.text
.globl pre_kernel
.p2align 8
.type pre_kernel,@function
pre_kernel:
  s_cmp_ge_u32 s2, 256
  s_cbranch_scc1 P_end2
  s_load_dwordx16 s[4:19], s[0:1], 0
  s_load_dwordx8 s[20:27], s[0:1], 64
  v_lshrrev_b32 v2, 6, v0
  v_and_b32 v1, 63, v0
  v_readfirstlane_b32 s28, v2
  v_subrev_u32 v0, 64, v0
  v_lshlrev_b32 v5, 4, v1
  v_lshlrev_b32 v6, 2, v1
  v_lshlrev_b32 v7, 2, v0
  s_cmp_ge_u32 s2, 208
  s_cbranch_scc1 P_init_only
  s_cmp_lg_u32 s28, 0
  s_cbranch_scc1 P_mv
  s_waitcnt lgkmcnt(0)
  s_mov_b32 s32, s4
  s_mov_b32 s33, s5
  s_mov_b32 s34, 1152
  s_mov_b32 s35, 0x00020000
  buffer_load_dwordx4 v[8:11], v5, s[32:35], 0 offen
  buffer_load_dword v12, v6, s[32:35], 0 offen offset:1024
  s_branch P_ln
P_mv:
  s_sub_u32 s29, s28, 1
  v_lshrrev_b32 v13, 3, v1
  v_and_b32 v14, 7, v1
  s_movk_i32 s59, 9216
  s_movk_i32 s64, 72
  s_cmp_ge_u32 s2, 144
  s_cselect_b32 s59, 8192, s59
  s_cselect_b32 s64, 144, s64
  s_cmp_lt_u32 s2, 72
  s_cselect_b32 s64, 0, s64
  s_sub_u32 s64, s2, s64
  v_mul_lo_u32 v4, v13, s59
  v_lshl_add_u32 v4, v14, 4, v4
  s_mul_i32 s65, s29, 72
  s_mul_i32 s65, s65, s59
  s_lshl_b32 s31, s64, 7
  s_add_u32 s65, s65, s31
  s_lshl_b32 s66, s59, 3
  s_mul_i32 s67, s29, 144
  s_mov_b32 s68, 16
  s_waitcnt lgkmcnt(0)
  s_cmp_lt_u32 s2, 72
  s_cselect_b32 s36, s16, s18
  s_cselect_b32 s37, s17, s19
  s_cmp_ge_u32 s2, 144
  s_cselect_b32 s36, s10, s36
  s_cselect_b32 s37, s11, s37
  s_mul_i32 s38, s59, 576
  s_mov_b32 s39, 0x00020000
P_common:
  buffer_load_dwordx4 v[64:67], v4, s[36:39], s65 offen nt
  s_add_u32 s65, s65, s66
  buffer_load_dwordx4 v[68:71], v4, s[36:39], s65 offen nt
  s_add_u32 s65, s65, s66
  buffer_load_dwordx4 v[72:75], v4, s[36:39], s65 offen nt
  s_add_u32 s65, s65, s66
  s_waitcnt vmcnt(2)
  buffer_load_dwordx4 v[76:79], v4, s[36:39], s65 offen nt
  s_add_u32 s65, s65, s66
  s_waitcnt vmcnt(2)
  buffer_load_dwordx4 v[80:83], v4, s[36:39], s65 offen nt
  s_add_u32 s65, s65, s66
  s_waitcnt vmcnt(2)
  buffer_load_dwordx4 v[84:87], v4, s[36:39], s65 offen nt
  s_add_u32 s65, s65, s66
  s_waitcnt vmcnt(2)
  buffer_load_dwordx4 v[88:91], v4, s[36:39], s65 offen nt
  s_add_u32 s65, s65, s66
  s_waitcnt vmcnt(2)
  buffer_load_dwordx4 v[92:95], v4, s[36:39], s65 offen nt
  s_add_u32 s65, s65, s66
  s_waitcnt vmcnt(2)
  buffer_load_dwordx4 v[96:99], v4, s[36:39], s65 offen nt
  s_add_u32 s65, s65, s66
  v_lshlrev_b32 v15, 1, v13
  v_add_u32 v15, s67, v15
  s_mov_b32 s44, s26
  s_mov_b32 s45, s27
  s_mov_b32 s46, 8388608
  s_mov_b32 s47, 0x00020000
  s_barrier
  ds_read_u16 v32, v15 offset:0
  v_add_u32 v15, s68, v15
  ds_read_u16 v33, v15 offset:0
  v_add_u32 v15, s68, v15
  ds_read_u16 v34, v15 offset:0
  v_add_u32 v15, s68, v15
  ds_read_u16 v35, v15 offset:0
  v_add_u32 v15, s68, v15
  ds_read_u16 v36, v15 offset:0
  v_add_u32 v15, s68, v15
  ds_read_u16 v37, v15 offset:0
  v_add_u32 v15, s68, v15
  ds_read_u16 v38, v15 offset:0
  v_add_u32 v15, s68, v15
  ds_read_u16 v39, v15 offset:0
  v_add_u32 v15, s68, v15
  ds_read_u16 v40, v15 offset:0
  v_add_u32 v15, s68, v15
  s_waitcnt lgkmcnt(0)
  s_waitcnt vmcnt(8)
  v_lshlrev_b32 v44, 16, v32
  v_dot2_f32_bf16 v16, v64, v32, 0
  v_dot2_f32_bf16 v17, v64, v44, 0
  v_dot2_f32_bf16 v18, v65, v32, 0
  v_dot2_f32_bf16 v19, v65, v44, 0
  v_dot2_f32_bf16 v20, v66, v32, 0
  v_dot2_f32_bf16 v21, v66, v44, 0
  v_dot2_f32_bf16 v22, v67, v32, 0
  v_dot2_f32_bf16 v23, v67, v44, 0
  s_waitcnt vmcnt(7)
  v_lshlrev_b32 v45, 16, v33
  v_dot2_f32_bf16 v16, v68, v33, v16
  v_dot2_f32_bf16 v17, v68, v45, v17
  v_dot2_f32_bf16 v18, v69, v33, v18
  v_dot2_f32_bf16 v19, v69, v45, v19
  v_dot2_f32_bf16 v20, v70, v33, v20
  v_dot2_f32_bf16 v21, v70, v45, v21
  v_dot2_f32_bf16 v22, v71, v33, v22
  v_dot2_f32_bf16 v23, v71, v45, v23
  s_waitcnt vmcnt(6)
  v_lshlrev_b32 v44, 16, v34
  v_dot2_f32_bf16 v16, v72, v34, v16
  v_dot2_f32_bf16 v17, v72, v44, v17
  v_dot2_f32_bf16 v18, v73, v34, v18
  v_dot2_f32_bf16 v19, v73, v44, v19
  v_dot2_f32_bf16 v20, v74, v34, v20
  v_dot2_f32_bf16 v21, v74, v44, v21
  v_dot2_f32_bf16 v22, v75, v34, v22
  v_dot2_f32_bf16 v23, v75, v44, v23
  s_waitcnt vmcnt(5)
  v_lshlrev_b32 v45, 16, v35
  v_dot2_f32_bf16 v16, v76, v35, v16
  v_dot2_f32_bf16 v17, v76, v45, v17
  v_dot2_f32_bf16 v18, v77, v35, v18
  v_dot2_f32_bf16 v19, v77, v45, v19
  v_dot2_f32_bf16 v20, v78, v35, v20
  v_dot2_f32_bf16 v21, v78, v45, v21
  v_dot2_f32_bf16 v22, v79, v35, v22
  v_dot2_f32_bf16 v23, v79, v45, v23
  s_waitcnt vmcnt(4)
  v_lshlrev_b32 v44, 16, v36
  v_dot2_f32_bf16 v16, v80, v36, v16
  v_dot2_f32_bf16 v17, v80, v44, v17
  v_dot2_f32_bf16 v18, v81, v36, v18
  v_dot2_f32_bf16 v19, v81, v44, v19
  v_dot2_f32_bf16 v20, v82, v36, v20
  v_dot2_f32_bf16 v21, v82, v44, v21
  v_dot2_f32_bf16 v22, v83, v36, v22
  v_dot2_f32_bf16 v23, v83, v44, v23
  s_waitcnt vmcnt(3)
  v_lshlrev_b32 v45, 16, v37
  v_dot2_f32_bf16 v16, v84, v37, v16
  v_dot2_f32_bf16 v17, v84, v45, v17
  v_dot2_f32_bf16 v18, v85, v37, v18
  v_dot2_f32_bf16 v19, v85, v45, v19
  v_dot2_f32_bf16 v20, v86, v37, v20
  v_dot2_f32_bf16 v21, v86, v45, v21
  v_dot2_f32_bf16 v22, v87, v37, v22
  v_dot2_f32_bf16 v23, v87, v45, v23
  s_waitcnt vmcnt(2)
  v_lshlrev_b32 v44, 16, v38
  v_dot2_f32_bf16 v16, v88, v38, v16
  v_dot2_f32_bf16 v17, v88, v44, v17
  v_dot2_f32_bf16 v18, v89, v38, v18
  v_dot2_f32_bf16 v19, v89, v44, v19
  v_dot2_f32_bf16 v20, v90, v38, v20
  v_dot2_f32_bf16 v21, v90, v44, v21
  v_dot2_f32_bf16 v22, v91, v38, v22
  v_dot2_f32_bf16 v23, v91, v44, v23
  s_waitcnt vmcnt(1)
  v_lshlrev_b32 v45, 16, v39
  v_dot2_f32_bf16 v16, v92, v39, v16
  v_dot2_f32_bf16 v17, v92, v45, v17
  v_dot2_f32_bf16 v18, v93, v39, v18
  v_dot2_f32_bf16 v19, v93, v45, v19
  v_dot2_f32_bf16 v20, v94, v39, v20
  v_dot2_f32_bf16 v21, v94, v45, v21
  v_dot2_f32_bf16 v22, v95, v39, v22
  v_dot2_f32_bf16 v23, v95, v45, v23
  s_waitcnt vmcnt(0)
  v_lshlrev_b32 v44, 16, v40
  v_dot2_f32_bf16 v16, v96, v40, v16
  v_dot2_f32_bf16 v17, v96, v44, v17
  v_dot2_f32_bf16 v18, v97, v40, v18
  v_dot2_f32_bf16 v19, v97, v44, v19
  v_dot2_f32_bf16 v20, v98, v40, v20
  v_dot2_f32_bf16 v21, v98, v44, v21
  v_dot2_f32_bf16 v22, v99, v40, v22
  v_dot2_f32_bf16 v23, v99, v44, v23
  v_lshlrev_b32 v15, 5, v14
  v_lshrrev_b32 v24, 4, v1
  v_lshl_add_u32 v15, v24, 3, v15
  s_lshl_b32 s31, s29, 8
  v_add_u32 v15, s31, v15
  v_permlane32_swap_b32 v16, v20
  v_permlane32_swap_b32 v17, v21
  v_permlane32_swap_b32 v18, v22
  v_permlane32_swap_b32 v19, v23
  s_nop 1
  v_add_f32 v16, v16, v20
  v_add_f32 v17, v17, v21
  v_add_f32 v18, v18, v22
  v_add_f32 v19, v19, v23
  s_nop 1
  v_permlane16_swap_b32 v16, v18
  v_permlane16_swap_b32 v17, v19
  s_nop 1
  v_add_f32 v16, v16, v18
  v_add_f32 v17, v17, v19
  s_nop 0
  v_add_f32_dpp v16, v16, v16 row_ror:8 row_mask:0xf bank_mask:0xf
  v_add_f32_dpp v17, v17, v17 row_ror:8 row_mask:0xf bank_mask:0xf
  ds_write_b64 v15, v[16:17] offset:1280
  s_waitcnt lgkmcnt(0)
  s_barrier
  s_cmp_lg_u32 s29, 0
  s_cbranch_scc1 P_end
  ds_read_b32 v16, v6 offset:1280
  ds_read_b32 v17, v6 offset:1536
  ds_read_b32 v18, v6 offset:1792
  ds_read_b32 v19, v6 offset:2048
  ds_read_b32 v20, v6 offset:2304
  ds_read_b32 v21, v6 offset:2560
  ds_read_b32 v22, v6 offset:2816
  ds_read_b32 v23, v6 offset:3072
  s_lshl_b32 s65, s2, 7
  s_add_u32 s65, s65, 1310720
  v_lshlrev_b32 v24, 1, v1
  s_waitcnt lgkmcnt(0)
  v_add_f32 v16, v16, v20
  v_add_f32 v17, v17, v21
  v_add_f32 v18, v18, v22
  v_add_f32 v19, v19, v23
  v_add_f32 v16, v16, v17
  v_add_f32 v18, v18, v19
  v_add_f32 v16, v16, v18
  v_cvt_pk_bf16_f32 v16, v16, v16
  buffer_store_short v16, v24, s[44:47], s65 offen
  s_branch P_end
P_ln:
  s_waitcnt vmcnt(0)
  v_lshlrev_b32 v16, 16, v8
  v_and_b32 v17, 0xffff0000, v8
  v_lshlrev_b32 v18, 16, v9
  v_and_b32 v19, 0xffff0000, v9
  v_lshlrev_b32 v20, 16, v10
  v_and_b32 v21, 0xffff0000, v10
  v_lshlrev_b32 v22, 16, v11
  v_and_b32 v23, 0xffff0000, v11
  v_lshlrev_b32 v24, 16, v12
  v_and_b32 v25, 0xffff0000, v12
  v_add_f32 v26, v16, v17
  v_add_f32 v26, v26, v18
  v_add_f32 v26, v26, v19
  v_add_f32 v26, v26, v20
  v_add_f32 v26, v26, v21
  v_add_f32 v26, v26, v22
  v_add_f32 v26, v26, v23
  v_add_f32 v26, v26, v24
  v_add_f32 v26, v26, v25
  s_nop 1
  v_add_f32_dpp v26, v26, v26 quad_perm:[1,0,3,2] row_mask:0xf bank_mask:0xf
  s_nop 1
  v_add_f32_dpp v26, v26, v26 quad_perm:[2,3,0,1] row_mask:0xf bank_mask:0xf
  s_nop 1
  v_add_f32_dpp v26, v26, v26 row_ror:4 row_mask:0xf bank_mask:0xf
  s_nop 1
  v_add_f32_dpp v26, v26, v26 row_ror:8 row_mask:0xf bank_mask:0xf
  s_nop 0
  v_mov_b32 v27, v26
  s_nop 1
  v_permlane16_swap_b32 v26, v27
  s_nop 1
  v_add_f32 v26, v26, v27
  v_mov_b32 v27, v26
  s_nop 1
  v_permlane32_swap_b32 v26, v27
  s_nop 1
  v_add_f32 v26, v26, v27
  s_mov_b32 s31, 0x3ae38e39
  v_mul_f32 v26, s31, v26
  v_sub_f32 v28, v16, v26
  v_mul_f32 v27, v28, v28
  v_sub_f32 v28, v17, v26
  v_fmac_f32 v27, v28, v28
  v_sub_f32 v28, v18, v26
  v_fmac_f32 v27, v28, v28
  v_sub_f32 v28, v19, v26
  v_fmac_f32 v27, v28, v28
  v_sub_f32 v28, v20, v26
  v_fmac_f32 v27, v28, v28
  v_sub_f32 v28, v21, v26
  v_fmac_f32 v27, v28, v28
  v_sub_f32 v28, v22, v26
  v_fmac_f32 v27, v28, v28
  v_sub_f32 v28, v23, v26
  v_fmac_f32 v27, v28, v28
  s_mov_b32 exec_hi, 0
  v_sub_f32 v28, v24, v26
  v_fmac_f32 v27, v28, v28
  v_sub_f32 v28, v25, v26
  v_fmac_f32 v27, v28, v28
  s_mov_b64 exec, -1
  s_nop 1
  v_add_f32_dpp v27, v27, v27 quad_perm:[1,0,3,2] row_mask:0xf bank_mask:0xf
  s_nop 1
  v_add_f32_dpp v27, v27, v27 quad_perm:[2,3,0,1] row_mask:0xf bank_mask:0xf
  s_nop 1
  v_add_f32_dpp v27, v27, v27 row_ror:4 row_mask:0xf bank_mask:0xf
  s_nop 1
  v_add_f32_dpp v27, v27, v27 row_ror:8 row_mask:0xf bank_mask:0xf
  s_nop 0
  v_mov_b32 v28, v27
  s_nop 1
  v_permlane16_swap_b32 v27, v28
  s_nop 1
  v_add_f32 v27, v27, v28
  v_mov_b32 v28, v27
  s_nop 1
  v_permlane32_swap_b32 v27, v28
  s_nop 1
  v_add_f32 v27, v27, v28
  v_mul_f32 v27, s31, v27
  v_cvt_pk_bf16_f32 v27, v27, v27
  v_lshlrev_b32 v27, 16, v27
  v_add_f32 v27, 0x3727c5ac, v27
  v_cvt_pk_bf16_f32 v27, v27, v27
  v_lshlrev_b32 v27, 16, v27
  v_sqrt_f32 v27, v27
  v_cvt_pk_bf16_f32 v26, v26, v26
  v_lshlrev_b32 v26, 16, v26
  v_cvt_pk_bf16_f32 v27, v27, v27
  v_lshlrev_b32 v27, 16, v27
  v_rcp_f32 v28, v27
  v_sub_f32 v16, v16, v26
  v_sub_f32 v17, v17, v26
  v_sub_f32 v18, v18, v26
  v_sub_f32 v19, v19, v26
  v_sub_f32 v20, v20, v26
  v_sub_f32 v21, v21, v26
  v_sub_f32 v22, v22, v26
  v_sub_f32 v23, v23, v26
  v_sub_f32 v24, v24, v26
  v_sub_f32 v25, v25, v26
  v_cvt_pk_bf16_f32 v8, v16, v17
  v_cvt_pk_bf16_f32 v9, v18, v19
  v_cvt_pk_bf16_f32 v10, v20, v21
  v_cvt_pk_bf16_f32 v11, v22, v23
  v_cvt_pk_bf16_f32 v12, v24, v25
  v_lshlrev_b32 v16, 16, v8
  v_and_b32 v17, 0xffff0000, v8
  v_lshlrev_b32 v18, 16, v9
  v_and_b32 v19, 0xffff0000, v9
  v_lshlrev_b32 v20, 16, v10
  v_and_b32 v21, 0xffff0000, v10
  v_lshlrev_b32 v22, 16, v11
  v_and_b32 v23, 0xffff0000, v11
  v_lshlrev_b32 v24, 16, v12
  v_and_b32 v25, 0xffff0000, v12
  v_mul_f32 v29, v16, v28
  v_fma_f32 v30, -v29, v27, v16
  v_fma_f32 v16, v30, v28, v29
  v_mul_f32 v29, v17, v28
  v_fma_f32 v30, -v29, v27, v17
  v_fma_f32 v17, v30, v28, v29
  v_mul_f32 v29, v18, v28
  v_fma_f32 v30, -v29, v27, v18
  v_fma_f32 v18, v30, v28, v29
  v_mul_f32 v29, v19, v28
  v_fma_f32 v30, -v29, v27, v19
  v_fma_f32 v19, v30, v28, v29
  v_mul_f32 v29, v20, v28
  v_fma_f32 v30, -v29, v27, v20
  v_fma_f32 v20, v30, v28, v29
  v_mul_f32 v29, v21, v28
  v_fma_f32 v30, -v29, v27, v21
  v_fma_f32 v21, v30, v28, v29
  v_mul_f32 v29, v22, v28
  v_fma_f32 v30, -v29, v27, v22
  v_fma_f32 v22, v30, v28, v29
  v_mul_f32 v29, v23, v28
  v_fma_f32 v30, -v29, v27, v23
  v_fma_f32 v23, v30, v28, v29
  v_mul_f32 v29, v24, v28
  v_fma_f32 v30, -v29, v27, v24
  v_fma_f32 v24, v30, v28, v29
  v_mul_f32 v29, v25, v28
  v_fma_f32 v30, -v29, v27, v25
  v_fma_f32 v25, v30, v28, v29
  v_cvt_pk_bf16_f32 v8, v16, v17
  v_cvt_pk_bf16_f32 v9, v18, v19
  v_cvt_pk_bf16_f32 v10, v20, v21
  v_cvt_pk_bf16_f32 v11, v22, v23
  v_cvt_pk_bf16_f32 v12, v24, v25
  ds_write_b128 v5, v[8:11] offset:0
  ds_write_b32 v6, v12 offset:1024
  s_waitcnt lgkmcnt(0)
  s_barrier
  s_branch P_end
P_init_only:
  s_sub_u32 s60, s2, 208
  s_mul_i32 s60, s60, 9
  s_add_u32 s60, s60, s28
  s_waitcnt lgkmcnt(0)
  s_cmp_ge_u32 s60, 256
  s_cbranch_scc1 P_end
  s_mov_b32 s44, s26
  s_mov_b32 s45, s27
  s_mov_b32 s46, 8388608
  s_mov_b32 s47, 0x00020000
  v_mov_b32 v20, -1
  v_mov_b32 v21, -1
  v_mov_b32 v22, -1
  v_mov_b32 v23, -1
  v_mov_b32 v24, 0
  s_lshl_b32 s62, s60, 11
  buffer_store_dwordx4 v[20:23], v5, s[44:47], s62 offen
  s_mul_i32 s63, s60, 2304
  s_add_u32 s63, s63, 1835008
  buffer_store_dwordx4 v[20:23], v5, s[44:47], s63 offen
  buffer_store_dwordx4 v[20:23], v5, s[44:47], s63 offen offset:1024
  buffer_store_dword v20, v6, s[44:47], s63 offen offset:2048
  s_lshl_b32 s63, s60, 8
  s_add_u32 s63, s63, 1048576
  buffer_store_dword v20, v6, s[44:47], s63 offen
  s_add_u32 s63, s63, 131072
  buffer_store_dword v20, v6, s[44:47], s63 offen
  s_mov_b64 exec, 15
  buffer_store_dword v20, v6, s[44:47], s62 offen offset:1024
P_end:
P_end2:
  s_endpgm
.globl recurrent_scan__gqa_block_cached__geglu_ffn__decode_kernel
.p2align 8
.type recurrent_scan__gqa_block_cached__geglu_ffn__decode_kernel,@function
recurrent_scan__gqa_block_cached__geglu_ffn__decode_kernel:
  s_cmp_ge_u32 s2, 256
  s_cbranch_scc1 L_end2
  s_load_dwordx16 s[4:19], s[0:1], 0
  s_load_dwordx8 s[20:27], s[0:1], 64
  v_lshrrev_b32 v2, 6, v0
  v_and_b32 v1, 63, v0
  v_readfirstlane_b32 s28, v2
  s_lshr_b32 s29, s2, 4
  s_and_b32 s30, s2, 15
  v_and_b32 v2, 15, v1
  v_lshrrev_b32 v3, 4, v1
  s_mov_b32 s56, 0x3fb8aa3b
  s_cmp_lt_u32 s28, 4
  s_cbranch_scc1 L_attn
  v_mov_b32 v16, 0
  ds_write_b32 v16, v16 offset:32960
  s_waitcnt lgkmcnt(0)
  s_barrier
  s_branch L_side
L_attn:
  v_lshrrev_b32 v10, 1, v2
  v_lshlrev_b32 v4, 8, v10
  v_lshl_add_u32 v4, v3, 5, v4
  v_and_b32 v11, 1, v2
  v_lshl_add_u32 v4, v11, 4, v4
  v_add_u32 v5, 0x1000, v4
  v_and_b32 v12, 1, v10
  v_lshlrev_b32 v12, 8, v12
  v_lshl_add_u32 v12, v3, 5, v12
  v_lshl_add_u32 v12, v11, 4, v12
  s_lshl_b32 s60, s29, 24
  s_lshl_b32 s61, s30, 20
  s_lshl_b32 s58, s28, 13
  s_add_u32 s62, s58, s61
  s_lshl_b32 s63, s29, 9
  s_add_u32 s63, s63, 1329152
  s_waitcnt lgkmcnt(0)
  s_mov_b32 s44, s26
  s_mov_b32 s45, s27
  s_mov_b32 s46, 8388608
  s_mov_b32 s47, 0x00020000
  s_add_u32 s32, s6, s60
  s_addc_u32 s33, s7, 0
  s_mov_b32 s34, 0x1000000
  s_mov_b32 s35, 0x00020000
  buffer_load_dwordx4 v[116:119], v12, s[44:47], s63 offen
  buffer_load_dwordx4 v[120:123], v12, s[44:47], s63 offen offset:128
  s_barrier
  buffer_load_dwordx4 v[16:19], v4, s[32:35], s62 offen offset:0 nt
  buffer_load_dwordx4 v[20:23], v4, s[32:35], s62 offen offset:128 nt
  buffer_load_dwordx4 v[24:27], v4, s[32:35], s62 offen offset:2048 nt
  buffer_load_dwordx4 v[28:31], v4, s[32:35], s62 offen offset:2176 nt
  buffer_load_dwordx4 v[32:35], v5, s[32:35], s62 offen offset:0 nt
  s_mov_b32 s61, s62
  s_add_u32 s63, s62, 0x8000
  s_add_u32 s36, s8, s60
  s_addc_u32 s37, s9, 0
  s_mov_b32 s38, 0x1000000
  s_mov_b32 s39, 0x00020000
  s_mov_b32 s52, 0x05040100
  s_mov_b32 s53, 0x07060302
  v_lshlrev_b32 v6, 11, v3
  v_lshl_add_u32 v6, v2, 4, v6
  s_lshl_b32 s31, s28, 13
  v_lshlrev_b32 v13, 2, v1
  v_add_u32 v7, s31, v13
  v_mov_b32 v8, 0xff800000
  v_mov_b32 v9, 0
  s_mov_b32 s54, 0xaaaaaaaa
  s_mov_b32 s55, 0xaaaaaaaa
  s_mov_b32 s57, 0x3db504f3
  v_and_b32 v11, 1, v10
  v_lshlrev_b32 v11, 4, v11
  v_mov_b32 v12, 0xffff
  v_lshlrev_b32 v12, v11, v12
  v_lshrrev_b32 v11, 1, v10
  v_cmp_eq_u32 vcc, 0, v11
  s_nop 1
  v_cndmask_b32 v124, 0, v12, vcc
  v_cmp_eq_u32 vcc, 1, v11
  s_nop 1
  v_cndmask_b32 v125, 0, v12, vcc
  v_cmp_eq_u32 vcc, 2, v11
  s_nop 1
  v_cndmask_b32 v126, 0, v12, vcc
  v_cmp_eq_u32 vcc, 3, v11
  s_nop 1
  v_cndmask_b32 v127, 0, v12, vcc
  s_mov_b32 s64, 0x000f000f
  s_mov_b32 s65, 0x000f000f
  s_mov_b32 s66, 0x00f000f0
  s_mov_b32 s67, 0x00f000f0
  s_mov_b32 s68, 0x0f000f00
  s_mov_b32 s69, 0x0f000f00
  s_mov_b32 s70, 0xf000f000
  s_mov_b32 s71, 0xf000f000
  v_mov_b32 v80, 0
  v_mov_b32 v81, 0
  v_mov_b32 v82, 0
  v_mov_b32 v83, 0
  v_mov_b32 v84, 0
  v_mov_b32 v85, 0
  v_mov_b32 v86, 0
  v_mov_b32 v87, 0
  v_mov_b32 v88, 0
  v_mov_b32 v89, 0
  v_mov_b32 v90, 0
  v_mov_b32 v91, 0
  v_mov_b32 v92, 0
  v_mov_b32 v93, 0
  v_mov_b32 v94, 0
  v_mov_b32 v95, 0
  v_mov_b32 v96, 0
  v_mov_b32 v97, 0
  v_mov_b32 v98, 0
  v_mov_b32 v99, 0
  v_mov_b32 v100, 0
  v_mov_b32 v101, 0
  v_mov_b32 v102, 0
  v_mov_b32 v103, 0
  v_mov_b32 v104, 0
  v_mov_b32 v105, 0
  v_mov_b32 v106, 0
  v_mov_b32 v107, 0
  v_mov_b32 v108, 0
  v_mov_b32 v109, 0
  v_mov_b32 v110, 0
  v_mov_b32 v111, 0
  s_waitcnt vmcnt(5)
  v_cndmask_b32 v48, 0, v116, s[64:65]
  v_cndmask_b32 v49, 0, v117, s[64:65]
  v_cndmask_b32 v50, 0, v118, s[64:65]
  v_cndmask_b32 v51, 0, v119, s[64:65]
  v_cndmask_b32 v52, 0, v120, s[64:65]
  v_cndmask_b32 v53, 0, v121, s[64:65]
  v_cndmask_b32 v54, 0, v122, s[64:65]
  v_cndmask_b32 v55, 0, v123, s[64:65]
  v_cndmask_b32 v56, 0, v116, s[66:67]
  v_cndmask_b32 v57, 0, v117, s[66:67]
  v_cndmask_b32 v58, 0, v118, s[66:67]
  v_cndmask_b32 v59, 0, v119, s[66:67]
  v_cndmask_b32 v60, 0, v120, s[66:67]
  v_cndmask_b32 v61, 0, v121, s[66:67]
  v_cndmask_b32 v62, 0, v122, s[66:67]
  v_cndmask_b32 v63, 0, v123, s[66:67]
  v_cndmask_b32 v64, 0, v116, s[68:69]
  v_cndmask_b32 v65, 0, v117, s[68:69]
  v_cndmask_b32 v66, 0, v118, s[68:69]
  v_cndmask_b32 v67, 0, v119, s[68:69]
  v_cndmask_b32 v68, 0, v120, s[68:69]
  v_cndmask_b32 v69, 0, v121, s[68:69]
  v_cndmask_b32 v70, 0, v122, s[68:69]
  v_cndmask_b32 v71, 0, v123, s[68:69]
  v_cndmask_b32 v72, 0, v116, s[70:71]
  v_cndmask_b32 v73, 0, v117, s[70:71]
  v_cndmask_b32 v74, 0, v118, s[70:71]
  v_cndmask_b32 v75, 0, v119, s[70:71]
  v_cndmask_b32 v76, 0, v120, s[70:71]
  v_cndmask_b32 v77, 0, v121, s[70:71]
  v_cndmask_b32 v78, 0, v122, s[70:71]
  v_cndmask_b32 v79, 0, v123, s[70:71]
  s_mov_b32 s72, 31
L_kloop:
  s_waitcnt vmcnt(4)
  buffer_load_dwordx4 v[36:39], v5, s[32:35], s62 offen offset:128 nt
  v_mfma_f32_16x16x32_bf16 v[112:115], v[48:51], v[16:19], 0
  s_waitcnt vmcnt(4)
  buffer_load_dwordx4 v[40:43], v5, s[32:35], s62 offen offset:2048 nt
  v_mfma_f32_16x16x32_bf16 v[112:115], v[52:55], v[20:23], v[112:115]
  s_waitcnt vmcnt(4)
  buffer_load_dwordx4 v[44:47], v5, s[32:35], s62 offen offset:2176 nt
  v_mfma_f32_16x16x32_bf16 v[112:115], v[56:59], v[24:27], v[112:115]
  s_waitcnt vmcnt(4)
  buffer_load_dwordx4 v[16:19], v4, s[32:35], s63 offen offset:0 nt
  v_mfma_f32_16x16x32_bf16 v[112:115], v[60:63], v[28:31], v[112:115]
  s_waitcnt vmcnt(4)
  buffer_load_dwordx4 v[20:23], v4, s[32:35], s63 offen offset:128 nt
  v_mfma_f32_16x16x32_bf16 v[112:115], v[64:67], v[32:35], v[112:115]
  s_waitcnt vmcnt(4)
  buffer_load_dwordx4 v[24:27], v4, s[32:35], s63 offen offset:2048 nt
  v_mfma_f32_16x16x32_bf16 v[112:115], v[68:71], v[36:39], v[112:115]
  s_waitcnt vmcnt(4)
  buffer_load_dwordx4 v[28:31], v4, s[32:35], s63 offen offset:2176 nt
  v_mfma_f32_16x16x32_bf16 v[112:115], v[72:75], v[40:43], v[112:115]
  s_waitcnt vmcnt(4)
  buffer_load_dwordx4 v[32:35], v5, s[32:35], s63 offen offset:0 nt
  v_mfma_f32_16x16x32_bf16 v[112:115], v[76:79], v[44:47], v[112:115]
  s_mov_b32 s62, s63
  s_add_u32 s63, s63, 0x8000
  s_nop 5
  v_cndmask_b32 v10, v112, v115, s[54:55]
  v_cndmask_b32 v11, v114, v113, s[54:55]
  s_nop 1
  v_add_f32_dpp v10, v11, v10 quad_perm:[1,0,3,2] row_mask:0xf bank_mask:0xf
  v_cvt_pk_bf16_f32 v10, v10, v10
  v_lshlrev_b32 v10, 16, v10
  v_mul_f32 v10, s57, v10
  v_cvt_pk_bf16_f32 v10, v10, v10
  v_lshlrev_b32 v10, 16, v10
  v_max_f32 v8, v8, v10
  ds_write_b32 v7, v10
  v_add_u32 v7, 0x100, v7
  s_sub_u32 s72, s72, 1
  s_cmp_lg_u32 s72, 0
  s_cbranch_scc1 L_kloop
  s_waitcnt vmcnt(4)
  buffer_load_dwordx4 v[36:39], v5, s[32:35], s62 offen offset:128 nt
  v_mfma_f32_16x16x32_bf16 v[112:115], v[48:51], v[16:19], 0
  s_waitcnt vmcnt(4)
  buffer_load_dwordx4 v[40:43], v5, s[32:35], s62 offen offset:2048 nt
  v_mfma_f32_16x16x32_bf16 v[112:115], v[52:55], v[20:23], v[112:115]
  s_waitcnt vmcnt(4)
  buffer_load_dwordx4 v[44:47], v5, s[32:35], s62 offen offset:2176 nt
  v_mfma_f32_16x16x32_bf16 v[112:115], v[56:59], v[24:27], v[112:115]
  s_waitcnt vmcnt(4)
  buffer_load_dwordx4 v[16:19], v6, s[36:39], s61 offen offset:0 nt
  v_mfma_f32_16x16x32_bf16 v[112:115], v[60:63], v[28:31], v[112:115]
  s_waitcnt vmcnt(4)
  buffer_load_dwordx4 v[20:23], v6, s[36:39], s61 offen offset:256 nt
  v_mfma_f32_16x16x32_bf16 v[112:115], v[64:67], v[32:35], v[112:115]
  s_waitcnt vmcnt(4)
  buffer_load_dwordx4 v[24:27], v6, s[36:39], s61 offen offset:512 nt
  v_mfma_f32_16x16x32_bf16 v[112:115], v[68:71], v[36:39], v[112:115]
  s_waitcnt vmcnt(4)
  buffer_load_dwordx4 v[28:31], v6, s[36:39], s61 offen offset:768 nt
  v_mfma_f32_16x16x32_bf16 v[112:115], v[72:75], v[40:43], v[112:115]
  s_waitcnt vmcnt(4)
  buffer_load_dwordx4 v[32:35], v6, s[36:39], s61 offen offset:1024 nt
  v_mfma_f32_16x16x32_bf16 v[112:115], v[76:79], v[44:47], v[112:115]
  s_mov_b32 s62, s63
  s_add_u32 s63, s63, 0x8000
  s_nop 5
  v_cndmask_b32 v10, v112, v115, s[54:55]
  v_cndmask_b32 v11, v114, v113, s[54:55]
  s_nop 1
  v_add_f32_dpp v10, v11, v10 quad_perm:[1,0,3,2] row_mask:0xf bank_mask:0xf
  v_cvt_pk_bf16_f32 v10, v10, v10
  v_lshlrev_b32 v10, 16, v10
  v_mul_f32 v10, s57, v10
  v_cvt_pk_bf16_f32 v10, v10, v10
  v_lshlrev_b32 v10, 16, v10
  v_max_f32 v8, v8, v10
  ds_write_b32 v7, v10
  v_add_u32 v7, 0x100, v7
  s_mov_b32 s62, s61
  s_add_u32 s63, s61, 0x8000
  v_subrev_u32 v7, 0x2000, v7
  ds_read_b32 v14, v7
  s_nop 1
  v_max_f32_dpp v8, v8, v8 quad_perm:[2,3,0,1] row_mask:0xf bank_mask:0xf
  s_nop 1
  v_max_f32_dpp v8, v8, v8 row_ror:4 row_mask:0xf bank_mask:0xf
  s_nop 1
  v_max_f32_dpp v8, v8, v8 row_ror:8 row_mask:0xf bank_mask:0xf
  s_nop 0
  v_mov_b32 v10, v8
  s_nop 1
  v_permlane16_swap_b32 v8, v10
  s_nop 1
  v_max_f32 v8, v8, v10
  v_mov_b32 v10, v8
  s_nop 1
  v_permlane32_swap_b32 v8, v10
  s_nop 1
  v_max_f32 v8, v8, v10
  s_mov_b32 s72, 27
L_vloop:
  s_waitcnt vmcnt(4)
  buffer_load_dwordx4 v[36:39], v6, s[36:39], s62 offen offset:1280 nt
  s_waitcnt vmcnt(4)
  buffer_load_dwordx4 v[40:43], v6, s[36:39], s62 offen offset:1536 nt
  v_perm_b32 v48, v20, v16, s52
  v_perm_b32 v52, v20, v16, s53
  v_perm_b32 v56, v21, v17, s52
  v_perm_b32 v60, v21, v17, s53
  v_perm_b32 v64, v22, v18, s52
  v_perm_b32 v68, v22, v18, s53
  v_perm_b32 v72, v23, v19, s52
  v_perm_b32 v76, v23, v19, s53
  s_waitcnt vmcnt(4)
  buffer_load_dwordx4 v[44:47], v6, s[36:39], s62 offen offset:1792 nt
  buffer_load_dwordx4 v[16:19], v6, s[36:39], s63 offen offset:0 nt
  s_waitcnt lgkmcnt(0)
  v_sub_f32 v10, v14, v8
  v_add_u32 v7, 0x100, v7
  v_mul_f32 v10, s56, v10
  ds_read_b32 v14, v7
  v_exp_f32 v10, v10
  s_nop 0
  v_add_f32 v9, v9, v10
  v_cvt_pk_bf16_f32 v10, v10, v10
  v_and_b32 v112, v10, v124
  v_and_b32 v113, v10, v125
  v_and_b32 v114, v10, v126
  v_and_b32 v115, v10, v127
  s_waitcnt vmcnt(5)
  v_perm_b32 v49, v28, v24, s52
  v_perm_b32 v53, v28, v24, s53
  v_perm_b32 v57, v29, v25, s52
  v_perm_b32 v61, v29, v25, s53
  v_perm_b32 v65, v30, v26, s52
  v_perm_b32 v69, v30, v26, s53
  v_perm_b32 v73, v31, v27, s52
  v_perm_b32 v77, v31, v27, s53
  s_waitcnt vmcnt(4)
  buffer_load_dwordx4 v[20:23], v6, s[36:39], s63 offen offset:256 nt
  s_waitcnt vmcnt(4)
  buffer_load_dwordx4 v[24:27], v6, s[36:39], s63 offen offset:512 nt
  v_perm_b32 v50, v36, v32, s52
  v_perm_b32 v54, v36, v32, s53
  v_perm_b32 v58, v37, v33, s52
  v_perm_b32 v62, v37, v33, s53
  v_perm_b32 v66, v38, v34, s52
  v_perm_b32 v70, v38, v34, s53
  v_perm_b32 v74, v39, v35, s52
  v_perm_b32 v78, v39, v35, s53
  s_waitcnt vmcnt(4)
  buffer_load_dwordx4 v[28:31], v6, s[36:39], s63 offen offset:768 nt
  buffer_load_dwordx4 v[32:35], v6, s[36:39], s63 offen offset:1024 nt
  s_waitcnt vmcnt(5)
  v_perm_b32 v51, v44, v40, s52
  v_perm_b32 v55, v44, v40, s53
  v_perm_b32 v59, v45, v41, s52
  v_perm_b32 v63, v45, v41, s53
  v_perm_b32 v67, v46, v42, s52
  v_perm_b32 v71, v46, v42, s53
  v_perm_b32 v75, v47, v43, s52
  v_perm_b32 v79, v47, v43, s53
  s_mov_b32 s62, s63
  s_add_u32 s63, s63, 0x8000
  v_mfma_f32_16x16x32_bf16 v[80:83], v[112:115], v[48:51], v[80:83]
  v_mfma_f32_16x16x32_bf16 v[84:87], v[112:115], v[52:55], v[84:87]
  v_mfma_f32_16x16x32_bf16 v[88:91], v[112:115], v[56:59], v[88:91]
  v_mfma_f32_16x16x32_bf16 v[92:95], v[112:115], v[60:63], v[92:95]
  v_mfma_f32_16x16x32_bf16 v[96:99], v[112:115], v[64:67], v[96:99]
  v_mfma_f32_16x16x32_bf16 v[100:103], v[112:115], v[68:71], v[100:103]
  v_mfma_f32_16x16x32_bf16 v[104:107], v[112:115], v[72:75], v[104:107]
  v_mfma_f32_16x16x32_bf16 v[108:111], v[112:115], v[76:79], v[108:111]
  s_sub_u32 s72, s72, 1
  s_cmp_lg_u32 s72, 0
  s_cbranch_scc1 L_vloop
  s_waitcnt vmcnt(4)
  buffer_load_dwordx4 v[36:39], v6, s[36:39], s62 offen offset:1280 nt
  s_waitcnt vmcnt(4)
  buffer_load_dwordx4 v[40:43], v6, s[36:39], s62 offen offset:1536 nt
  v_perm_b32 v48, v20, v16, s52
  v_perm_b32 v52, v20, v16, s53
  v_perm_b32 v56, v21, v17, s52
  v_perm_b32 v60, v21, v17, s53
  v_perm_b32 v64, v22, v18, s52
  v_perm_b32 v68, v22, v18, s53
  v_perm_b32 v72, v23, v19, s52
  v_perm_b32 v76, v23, v19, s53
  s_waitcnt vmcnt(4)
  buffer_load_dwordx4 v[44:47], v6, s[36:39], s62 offen offset:1792 nt
  buffer_load_dwordx4 v[16:19], v6, s[36:39], s63 offen offset:0 nt
  s_waitcnt lgkmcnt(0)
  v_sub_f32 v10, v14, v8
  v_add_u32 v7, 0x100, v7
  v_mul_f32 v10, s56, v10
  ds_read_b32 v14, v7
  v_exp_f32 v10, v10
  s_nop 0
  v_add_f32 v9, v9, v10
  v_cvt_pk_bf16_f32 v10, v10, v10
  v_and_b32 v112, v10, v124
  v_and_b32 v113, v10, v125
  v_and_b32 v114, v10, v126
  v_and_b32 v115, v10, v127
  s_waitcnt vmcnt(5)
  v_perm_b32 v49, v28, v24, s52
  v_perm_b32 v53, v28, v24, s53
  v_perm_b32 v57, v29, v25, s52
  v_perm_b32 v61, v29, v25, s53
  v_perm_b32 v65, v30, v26, s52
  v_perm_b32 v69, v30, v26, s53
  v_perm_b32 v73, v31, v27, s52
  v_perm_b32 v77, v31, v27, s53
  s_waitcnt vmcnt(4)
  buffer_load_dwordx4 v[20:23], v6, s[36:39], s63 offen offset:256 nt
  s_waitcnt vmcnt(4)
  buffer_load_dwordx4 v[24:27], v6, s[36:39], s63 offen offset:512 nt
  v_perm_b32 v50, v36, v32, s52
  v_perm_b32 v54, v36, v32, s53
  v_perm_b32 v58, v37, v33, s52
  v_perm_b32 v62, v37, v33, s53
  v_perm_b32 v66, v38, v34, s52
  v_perm_b32 v70, v38, v34, s53
  v_perm_b32 v74, v39, v35, s52
  v_perm_b32 v78, v39, v35, s53
  s_waitcnt vmcnt(4)
  buffer_load_dwordx4 v[28:31], v6, s[36:39], s63 offen offset:768 nt
  buffer_load_dwordx4 v[32:35], v6, s[36:39], s63 offen offset:1024 nt
  s_waitcnt vmcnt(5)
  v_perm_b32 v51, v44, v40, s52
  v_perm_b32 v55, v44, v40, s53
  v_perm_b32 v59, v45, v41, s52
  v_perm_b32 v63, v45, v41, s53
  v_perm_b32 v67, v46, v42, s52
  v_perm_b32 v71, v46, v42, s53
  v_perm_b32 v75, v47, v43, s52
  v_perm_b32 v79, v47, v43, s53
  buffer_load_dwordx4 v[36:39], v6, s[36:39], s63 offen offset:1280 nt
  buffer_load_dwordx4 v[40:43], v6, s[36:39], s63 offen offset:1536 nt
  buffer_load_dwordx4 v[44:47], v6, s[36:39], s63 offen offset:1792 nt
  s_mov_b32 s62, s63
  s_add_u32 s63, s63, 0x8000
  v_mfma_f32_16x16x32_bf16 v[80:83], v[112:115], v[48:51], v[80:83]
  v_mfma_f32_16x16x32_bf16 v[84:87], v[112:115], v[52:55], v[84:87]
  v_mfma_f32_16x16x32_bf16 v[88:91], v[112:115], v[56:59], v[88:91]
  v_mfma_f32_16x16x32_bf16 v[92:95], v[112:115], v[60:63], v[92:95]
  v_mfma_f32_16x16x32_bf16 v[96:99], v[112:115], v[64:67], v[96:99]
  v_mfma_f32_16x16x32_bf16 v[100:103], v[112:115], v[68:71], v[100:103]
  v_mfma_f32_16x16x32_bf16 v[104:107], v[112:115], v[72:75], v[104:107]
  v_mfma_f32_16x16x32_bf16 v[108:111], v[112:115], v[76:79], v[108:111]
  s_mov_b32 s72, 3
L_vloop2:
  s_waitcnt vmcnt(6)
  v_perm_b32 v48, v20, v16, s52
  v_perm_b32 v52, v20, v16, s53
  v_perm_b32 v56, v21, v17, s52
  v_perm_b32 v60, v21, v17, s53
  v_perm_b32 v64, v22, v18, s52
  v_perm_b32 v68, v22, v18, s53
  v_perm_b32 v72, v23, v19, s52
  v_perm_b32 v76, v23, v19, s53
  buffer_load_dwordx4 v[16:19], v6, s[36:39], s63 offen offset:0 nt
  buffer_load_dwordx4 v[20:23], v6, s[36:39], s63 offen offset:256 nt
  s_waitcnt lgkmcnt(0)
  v_sub_f32 v10, v14, v8
  v_add_u32 v7, 0x100, v7
  v_mul_f32 v10, s56, v10
  ds_read_b32 v14, v7
  v_exp_f32 v10, v10
  s_nop 0
  v_add_f32 v9, v9, v10
  v_cvt_pk_bf16_f32 v10, v10, v10
  v_and_b32 v112, v10, v124
  v_and_b32 v113, v10, v125
  v_and_b32 v114, v10, v126
  v_and_b32 v115, v10, v127
  s_waitcnt vmcnt(6)
  v_perm_b32 v49, v28, v24, s52
  v_perm_b32 v53, v28, v24, s53
  v_perm_b32 v57, v29, v25, s52
  v_perm_b32 v61, v29, v25, s53
  v_perm_b32 v65, v30, v26, s52
  v_perm_b32 v69, v30, v26, s53
  v_perm_b32 v73, v31, v27, s52
  v_perm_b32 v77, v31, v27, s53
  buffer_load_dwordx4 v[24:27], v6, s[36:39], s63 offen offset:512 nt
  buffer_load_dwordx4 v[28:31], v6, s[36:39], s63 offen offset:768 nt
  s_waitcnt vmcnt(6)
  v_perm_b32 v50, v36, v32, s52
  v_perm_b32 v54, v36, v32, s53
  v_perm_b32 v58, v37, v33, s52
  v_perm_b32 v62, v37, v33, s53
  v_perm_b32 v66, v38, v34, s52
  v_perm_b32 v70, v38, v34, s53
  v_perm_b32 v74, v39, v35, s52
  v_perm_b32 v78, v39, v35, s53
  buffer_load_dwordx4 v[32:35], v6, s[36:39], s63 offen offset:1024 nt
  buffer_load_dwordx4 v[36:39], v6, s[36:39], s63 offen offset:1280 nt
  s_waitcnt vmcnt(6)
  v_perm_b32 v51, v44, v40, s52
  v_perm_b32 v55, v44, v40, s53
  v_perm_b32 v59, v45, v41, s52
  v_perm_b32 v63, v45, v41, s53
  v_perm_b32 v67, v46, v42, s52
  v_perm_b32 v71, v46, v42, s53
  v_perm_b32 v75, v47, v43, s52
  v_perm_b32 v79, v47, v43, s53
  buffer_load_dwordx4 v[40:43], v6, s[36:39], s63 offen offset:1536 nt
  buffer_load_dwordx4 v[44:47], v6, s[36:39], s63 offen offset:1792 nt
  s_mov_b32 s62, s63
  s_add_u32 s63, s63, 0x8000
  v_mfma_f32_16x16x32_bf16 v[80:83], v[112:115], v[48:51], v[80:83]
  v_mfma_f32_16x16x32_bf16 v[84:87], v[112:115], v[52:55], v[84:87]
  v_mfma_f32_16x16x32_bf16 v[88:91], v[112:115], v[56:59], v[88:91]
  v_mfma_f32_16x16x32_bf16 v[92:95], v[112:115], v[60:63], v[92:95]
  v_mfma_f32_16x16x32_bf16 v[96:99], v[112:115], v[64:67], v[96:99]
  v_mfma_f32_16x16x32_bf16 v[100:103], v[112:115], v[68:71], v[100:103]
  v_mfma_f32_16x16x32_bf16 v[104:107], v[112:115], v[72:75], v[104:107]
  v_mfma_f32_16x16x32_bf16 v[108:111], v[112:115], v[76:79], v[108:111]
  s_sub_u32 s72, s72, 1
  s_cmp_lg_u32 s72, 0
  s_cbranch_scc1 L_vloop2
  s_waitcnt vmcnt(6)
  v_perm_b32 v48, v20, v16, s52
  v_perm_b32 v52, v20, v16, s53
  v_perm_b32 v56, v21, v17, s52
  v_perm_b32 v60, v21, v17, s53
  v_perm_b32 v64, v22, v18, s52
  v_perm_b32 v68, v22, v18, s53
  v_perm_b32 v72, v23, v19, s52
  v_perm_b32 v76, v23, v19, s53
  s_waitcnt lgkmcnt(0)
  v_sub_f32 v10, v14, v8
  v_mul_f32 v10, s56, v10
  v_exp_f32 v10, v10
  s_nop 0
  v_add_f32 v9, v9, v10
  v_cvt_pk_bf16_f32 v10, v10, v10
  v_and_b32 v112, v10, v124
  v_and_b32 v113, v10, v125
  v_and_b32 v114, v10, v126
  v_and_b32 v115, v10, v127
  s_waitcnt vmcnt(4)
  v_perm_b32 v49, v28, v24, s52
  v_perm_b32 v53, v28, v24, s53
  v_perm_b32 v57, v29, v25, s52
  v_perm_b32 v61, v29, v25, s53
  v_perm_b32 v65, v30, v26, s52
  v_perm_b32 v69, v30, v26, s53
  v_perm_b32 v73, v31, v27, s52
  v_perm_b32 v77, v31, v27, s53
  s_nop 1
  v_add_f32_dpp v9, v9, v9 quad_perm:[2,3,0,1] row_mask:0xf bank_mask:0xf
  s_nop 1
  v_add_f32_dpp v9, v9, v9 row_ror:4 row_mask:0xf bank_mask:0xf
  s_nop 1
  v_add_f32_dpp v9, v9, v9 row_ror:8 row_mask:0xf bank_mask:0xf
  s_nop 0
  v_mov_b32 v10, v9
  s_nop 1
  v_permlane16_swap_b32 v9, v10
  s_nop 1
  v_add_f32 v9, v9, v10
  v_mov_b32 v10, v9
  s_nop 1
  v_permlane32_swap_b32 v9, v10
  s_nop 1
  v_add_f32 v9, v9, v10
  s_lshl_b32 s31, s28, 4
  v_add_u32 v10, s31, v13
  s_mov_b64 exec, 3
  ds_write_b32 v10, v8 offset:32768
  ds_write_b32 v10, v9 offset:32776
  s_mov_b64 exec, -1
  s_waitcnt vmcnt(2)
  v_perm_b32 v50, v36, v32, s52
  v_perm_b32 v54, v36, v32, s53
  v_perm_b32 v58, v37, v33, s52
  v_perm_b32 v62, v37, v33, s53
  v_perm_b32 v66, v38, v34, s52
  v_perm_b32 v70, v38, v34, s53
  v_perm_b32 v74, v39, v35, s52
  v_perm_b32 v78, v39, v35, s53
  s_waitcnt vmcnt(0)
  v_perm_b32 v51, v44, v40, s52
  v_perm_b32 v55, v44, v40, s53
  v_perm_b32 v59, v45, v41, s52
  v_perm_b32 v63, v45, v41, s53
  v_perm_b32 v67, v46, v42, s52
  v_perm_b32 v71, v46, v42, s53
  v_perm_b32 v75, v47, v43, s52
  v_perm_b32 v79, v47, v43, s53
  s_mov_b32 s62, s63
  s_add_u32 s63, s63, 0x8000
  v_mfma_f32_16x16x32_bf16 v[80:83], v[112:115], v[48:51], v[80:83]
  v_mfma_f32_16x16x32_bf16 v[84:87], v[112:115], v[52:55], v[84:87]
  v_mfma_f32_16x16x32_bf16 v[88:91], v[112:115], v[56:59], v[88:91]
  v_mfma_f32_16x16x32_bf16 v[92:95], v[112:115], v[60:63], v[92:95]
  v_mfma_f32_16x16x32_bf16 v[96:99], v[112:115], v[64:67], v[96:99]
  v_mfma_f32_16x16x32_bf16 v[100:103], v[112:115], v[68:71], v[100:103]
  v_mfma_f32_16x16x32_bf16 v[104:107], v[112:115], v[72:75], v[104:107]
  v_mfma_f32_16x16x32_bf16 v[108:111], v[112:115], v[76:79], v[108:111]
  v_lshrrev_b32 v10, 1, v3
  v_lshlrev_b32 v10, 9, v10
  v_lshl_add_u32 v10, v2, 5, v10
  v_and_b32 v11, 1, v3
  v_lshl_add_u32 v10, v11, 4, v10
  s_lshl_b32 s31, s28, 13
  v_add_u32 v10, s31, v10
  s_nop 1
  v_add_f32 v16, v80, v82
  v_add_f32 v24, v81, v83
  v_add_f32 v17, v84, v86
  v_add_f32 v25, v85, v87
  v_add_f32 v18, v88, v90
  v_add_f32 v26, v89, v91
  v_add_f32 v19, v92, v94
  v_add_f32 v27, v93, v95
  v_add_f32 v20, v96, v98
  v_add_f32 v28, v97, v99
  v_add_f32 v21, v100, v102
  v_add_f32 v29, v101, v103
  v_add_f32 v22, v104, v106
  v_add_f32 v30, v105, v107
  v_add_f32 v23, v108, v110
  v_add_f32 v31, v109, v111
  s_nop 0
  v_permlane32_swap_b32 v16, v24
  v_permlane32_swap_b32 v17, v25
  v_permlane32_swap_b32 v18, v26
  v_permlane32_swap_b32 v19, v27
  v_permlane32_swap_b32 v20, v28
  v_permlane32_swap_b32 v21, v29
  v_permlane32_swap_b32 v22, v30
  v_permlane32_swap_b32 v23, v31
  s_nop 0
  v_add_f32 v16, v16, v24
  v_add_f32 v17, v17, v25
  v_add_f32 v18, v18, v26
  v_add_f32 v19, v19, v27
  v_add_f32 v20, v20, v28
  v_add_f32 v21, v21, v29
  v_add_f32 v22, v22, v30
  v_add_f32 v23, v23, v31
  s_nop 0
  v_permlane16_swap_b32 v16, v20
  v_permlane16_swap_b32 v17, v21
  v_permlane16_swap_b32 v18, v22
  v_permlane16_swap_b32 v19, v23
  s_nop 0
  v_add_f32 v16, v16, v20
  v_add_f32 v17, v17, v21
  v_add_f32 v18, v18, v22
  v_add_f32 v19, v19, v23
  ds_write_b128 v10, v[16:19]
  s_waitcnt lgkmcnt(0)
  s_barrier
  s_branch L_tail
L_side:
  s_cmp_lg_u32 s28, 7
  s_cbranch_scc1 L_nodown
  v_lshlrev_b32 v5, 4, v1
  v_lshlrev_b32 v6, 2, v1
  v_lshrrev_b32 v8, 3, v1
  v_and_b32 v9, 7, v1
  v_mul_u32_u24 v4, 1152, v8
  v_lshl_add_u32 v4, v9, 4, v4
  v_lshlrev_b32 v8, 2, v8
  s_mul_i32 s62, s2, 20736
  s_mul_i32 s63, s2, 36
  s_add_u32 s63, s63, 1310720
  v_lshlrev_b32 v7, 1, v1
  s_mov_b32 s44, s26
  s_mov_b32 s45, s27
  s_mov_b32 s46, 8388608
  s_mov_b32 s47, 0x00020000
  s_mov_b32 s36, s20
  s_mov_b32 s37, s21
  s_add_u32 s38, s62, 20736
  s_mov_b32 s39, 0x00020000
  buffer_load_ushort v10, v7, s[44:47], s63 offen
  s_add_u32 s63, s63, 9216
  buffer_load_ushort v11, v7, s[44:47], s63 offen
  s_mov_b32 s64, s62
  buffer_load_dwordx4 v[104:107], v4, s[36:39], s64 offen offset:1024 nt
  s_add_u32 s64, s64, 9216
  buffer_load_dwordx4 v[108:111], v4, s[36:39], s64 offen offset:1024 nt
  s_add_u32 s64, s64, 9216
  buffer_load_dwordx4 v[112:115], v4, s[36:39], s64 offen offset:1024 nt
  s_add_u32 s64, s64, 9216
  buffer_load_dwordx4 v[32:35], v5, s[36:39], s62 offen offset:0 nt
  buffer_load_dwordx4 v[36:39], v5, s[36:39], s62 offen offset:1152 nt
  buffer_load_dwordx4 v[40:43], v5, s[36:39], s62 offen offset:2304 nt
  s_add_u32 s62, s62, 3456
  buffer_load_dwordx4 v[44:47], v5, s[36:39], s62 offen offset:0 nt
  buffer_load_dwordx4 v[48:51], v5, s[36:39], s62 offen offset:1152 nt
  buffer_load_dwordx4 v[52:55], v5, s[36:39], s62 offen offset:2304 nt
  s_add_u32 s62, s62, 3456
  buffer_load_dwordx4 v[56:59], v5, s[36:39], s62 offen offset:0 nt
  buffer_load_dwordx4 v[60:63], v5, s[36:39], s62 offen offset:1152 nt
  buffer_load_dwordx4 v[64:67], v5, s[36:39], s62 offen offset:2304 nt
  s_add_u32 s62, s62, 3456
  buffer_load_dwordx4 v[68:71], v5, s[36:39], s62 offen offset:0 nt
  buffer_load_dwordx4 v[72:75], v5, s[36:39], s62 offen offset:1152 nt
  buffer_load_dwordx4 v[76:79], v5, s[36:39], s62 offen offset:2304 nt
  s_add_u32 s62, s62, 3456
  buffer_load_dwordx4 v[80:83], v5, s[36:39], s62 offen offset:0 nt
  buffer_load_dwordx4 v[84:87], v5, s[36:39], s62 offen offset:1152 nt
  buffer_load_dwordx4 v[88:91], v5, s[36:39], s62 offen offset:2304 nt
  s_add_u32 s62, s62, 3456
  buffer_load_dwordx4 v[92:95], v5, s[36:39], s62 offen offset:0 nt
  buffer_load_dwordx4 v[96:99], v5, s[36:39], s62 offen offset:1152 nt
  buffer_load_dwordx4 v[100:103], v5, s[36:39], s62 offen offset:2304 nt
  s_add_u32 s62, s62, 3456
  s_waitcnt vmcnt(21)
  v_lshlrev_b32 v10, 16, v10
  v_lshlrev_b32 v11, 16, v11
  v_mul_f32 v12, v10, v10
  v_mul_f32 v12, v12, v10
  v_mov_b32 v13, 0x3d372713
  v_fma_f32 v12, v12, v13, v10
  v_mul_f32 v12, 0xc0135761, v12
  v_exp_f32 v12, v12
  s_nop 0
  v_add_f32 v12, 1.0, v12
  v_rcp_f32 v12, v12
  s_nop 0
  v_mul_f32 v12, v10, v12
  v_cvt_pk_bf16_f32 v12, v12, v12
  v_lshlrev_b32 v12, 16, v12
  v_mul_f32 v12, v12, v11
  v_cvt_pk_bf16_f32 v10, v12, v12
  v_lshlrev_b32 v10, 16, v10
  v_cmp_gt_u32 vcc, 18, v1
  s_nop 1
  v_cndmask_b32 v10, 0, v10, vcc
  ds_bpermute_b32 v11, v8, v10 offset:0
  ds_bpermute_b32 v12, v8, v10 offset:32
  ds_bpermute_b32 v13, v8, v10 offset:64
  s_waitcnt vmcnt(18) lgkmcnt(0)
  v_lshrrev_b32 v14, 16, v11
  v_dot2_f32_bf16 v24, v104, v14, 0
  v_dot2_f32_bf16 v25, v104, v11, 0
  v_dot2_f32_bf16 v26, v105, v14, 0
  v_dot2_f32_bf16 v27, v105, v11, 0
  v_dot2_f32_bf16 v28, v106, v14, 0
  v_dot2_f32_bf16 v29, v106, v11, 0
  v_dot2_f32_bf16 v30, v107, v14, 0
  v_dot2_f32_bf16 v31, v107, v11, 0
  v_lshrrev_b32 v14, 16, v12
  v_dot2_f32_bf16 v24, v108, v14, v24
  v_dot2_f32_bf16 v25, v108, v12, v25
  v_dot2_f32_bf16 v26, v109, v14, v26
  v_dot2_f32_bf16 v27, v109, v12, v27
  v_dot2_f32_bf16 v28, v110, v14, v28
  v_dot2_f32_bf16 v29, v110, v12, v29
  v_dot2_f32_bf16 v30, v111, v14, v30
  v_dot2_f32_bf16 v31, v111, v12, v31
  v_lshrrev_b32 v14, 16, v13
  v_dot2_f32_bf16 v24, v112, v14, v24
  v_dot2_f32_bf16 v25, v112, v13, v25
  v_dot2_f32_bf16 v26, v113, v14, v26
  v_dot2_f32_bf16 v27, v113, v13, v27
  v_dot2_f32_bf16 v28, v114, v14, v28
  v_dot2_f32_bf16 v29, v114, v13, v29
  v_dot2_f32_bf16 v30, v115, v14, v30
  v_dot2_f32_bf16 v31, v115, v13, v31
  v_readlane_b32 s66, v10, 0
  s_waitcnt vmcnt(17)
  s_lshr_b32 s67, s66, 16
  s_nop 0
  v_dot2_f32_bf16 v16, v32, s67, 0
  v_dot2_f32_bf16 v17, v32, s66, 0
  v_dot2_f32_bf16 v18, v33, s67, 0
  v_dot2_f32_bf16 v19, v33, s66, 0
  v_dot2_f32_bf16 v20, v34, s67, 0
  v_dot2_f32_bf16 v21, v34, s66, 0
  v_dot2_f32_bf16 v22, v35, s67, 0
  v_dot2_f32_bf16 v23, v35, s66, 0
  v_readlane_b32 s68, v10, 1
  s_waitcnt vmcnt(16)
  s_lshr_b32 s69, s68, 16
  s_nop 0
  v_dot2_f32_bf16 v16, v36, s69, v16
  v_dot2_f32_bf16 v17, v36, s68, v17
  v_dot2_f32_bf16 v18, v37, s69, v18
  v_dot2_f32_bf16 v19, v37, s68, v19
  v_dot2_f32_bf16 v20, v38, s69, v20
  v_dot2_f32_bf16 v21, v38, s68, v21
  v_dot2_f32_bf16 v22, v39, s69, v22
  v_dot2_f32_bf16 v23, v39, s68, v23
  v_readlane_b32 s66, v10, 2
  s_waitcnt vmcnt(15)
  s_lshr_b32 s67, s66, 16
  s_nop 0
  v_dot2_f32_bf16 v16, v40, s67, v16
  v_dot2_f32_bf16 v17, v40, s66, v17
  v_dot2_f32_bf16 v18, v41, s67, v18
  v_dot2_f32_bf16 v19, v41, s66, v19
  v_dot2_f32_bf16 v20, v42, s67, v20
  v_dot2_f32_bf16 v21, v42, s66, v21
  v_dot2_f32_bf16 v22, v43, s67, v22
  v_dot2_f32_bf16 v23, v43, s66, v23
  v_readlane_b32 s68, v10, 3
  s_waitcnt vmcnt(14)
  s_lshr_b32 s69, s68, 16
  s_nop 0
  v_dot2_f32_bf16 v16, v44, s69, v16
  v_dot2_f32_bf16 v17, v44, s68, v17
  v_dot2_f32_bf16 v18, v45, s69, v18
  v_dot2_f32_bf16 v19, v45, s68, v19
  v_dot2_f32_bf16 v20, v46, s69, v20
  v_dot2_f32_bf16 v21, v46, s68, v21
  v_dot2_f32_bf16 v22, v47, s69, v22
  v_dot2_f32_bf16 v23, v47, s68, v23
  v_readlane_b32 s66, v10, 4
  s_waitcnt vmcnt(13)
  s_lshr_b32 s67, s66, 16
  s_nop 0
  v_dot2_f32_bf16 v16, v48, s67, v16
  v_dot2_f32_bf16 v17, v48, s66, v17
  v_dot2_f32_bf16 v18, v49, s67, v18
  v_dot2_f32_bf16 v19, v49, s66, v19
  v_dot2_f32_bf16 v20, v50, s67, v20
  v_dot2_f32_bf16 v21, v50, s66, v21
  v_dot2_f32_bf16 v22, v51, s67, v22
  v_dot2_f32_bf16 v23, v51, s66, v23
  v_readlane_b32 s68, v10, 5
  s_waitcnt vmcnt(12)
  s_lshr_b32 s69, s68, 16
  s_nop 0
  v_dot2_f32_bf16 v16, v52, s69, v16
  v_dot2_f32_bf16 v17, v52, s68, v17
  v_dot2_f32_bf16 v18, v53, s69, v18
  v_dot2_f32_bf16 v19, v53, s68, v19
  v_dot2_f32_bf16 v20, v54, s69, v20
  v_dot2_f32_bf16 v21, v54, s68, v21
  v_dot2_f32_bf16 v22, v55, s69, v22
  v_dot2_f32_bf16 v23, v55, s68, v23
  v_readlane_b32 s66, v10, 6
  s_waitcnt vmcnt(11)
  s_lshr_b32 s67, s66, 16
  s_nop 0
  v_dot2_f32_bf16 v16, v56, s67, v16
  v_dot2_f32_bf16 v17, v56, s66, v17
  v_dot2_f32_bf16 v18, v57, s67, v18
  v_dot2_f32_bf16 v19, v57, s66, v19
  v_dot2_f32_bf16 v20, v58, s67, v20
  v_dot2_f32_bf16 v21, v58, s66, v21
  v_dot2_f32_bf16 v22, v59, s67, v22
  v_dot2_f32_bf16 v23, v59, s66, v23
  v_readlane_b32 s68, v10, 7
  s_waitcnt vmcnt(10)
  s_lshr_b32 s69, s68, 16
  s_nop 0
  v_dot2_f32_bf16 v16, v60, s69, v16
  v_dot2_f32_bf16 v17, v60, s68, v17
  v_dot2_f32_bf16 v18, v61, s69, v18
  v_dot2_f32_bf16 v19, v61, s68, v19
  v_dot2_f32_bf16 v20, v62, s69, v20
  v_dot2_f32_bf16 v21, v62, s68, v21
  v_dot2_f32_bf16 v22, v63, s69, v22
  v_dot2_f32_bf16 v23, v63, s68, v23
  v_readlane_b32 s66, v10, 8
  s_waitcnt vmcnt(9)
  s_lshr_b32 s67, s66, 16
  s_nop 0
  v_dot2_f32_bf16 v16, v64, s67, v16
  v_dot2_f32_bf16 v17, v64, s66, v17
  v_dot2_f32_bf16 v18, v65, s67, v18
  v_dot2_f32_bf16 v19, v65, s66, v19
  v_dot2_f32_bf16 v20, v66, s67, v20
  v_dot2_f32_bf16 v21, v66, s66, v21
  v_dot2_f32_bf16 v22, v67, s67, v22
  v_dot2_f32_bf16 v23, v67, s66, v23
  v_readlane_b32 s68, v10, 9
  s_waitcnt vmcnt(8)
  s_lshr_b32 s69, s68, 16
  s_nop 0
  v_dot2_f32_bf16 v16, v68, s69, v16
  v_dot2_f32_bf16 v17, v68, s68, v17
  v_dot2_f32_bf16 v18, v69, s69, v18
  v_dot2_f32_bf16 v19, v69, s68, v19
  v_dot2_f32_bf16 v20, v70, s69, v20
  v_dot2_f32_bf16 v21, v70, s68, v21
  v_dot2_f32_bf16 v22, v71, s69, v22
  v_dot2_f32_bf16 v23, v71, s68, v23
  v_readlane_b32 s66, v10, 10
  s_waitcnt vmcnt(7)
  s_lshr_b32 s67, s66, 16
  s_nop 0
  v_dot2_f32_bf16 v16, v72, s67, v16
  v_dot2_f32_bf16 v17, v72, s66, v17
  v_dot2_f32_bf16 v18, v73, s67, v18
  v_dot2_f32_bf16 v19, v73, s66, v19
  v_dot2_f32_bf16 v20, v74, s67, v20
  v_dot2_f32_bf16 v21, v74, s66, v21
  v_dot2_f32_bf16 v22, v75, s67, v22
  v_dot2_f32_bf16 v23, v75, s66, v23
  v_readlane_b32 s68, v10, 11
  s_waitcnt vmcnt(6)
  s_lshr_b32 s69, s68, 16
  s_nop 0
  v_dot2_f32_bf16 v16, v76, s69, v16
  v_dot2_f32_bf16 v17, v76, s68, v17
  v_dot2_f32_bf16 v18, v77, s69, v18
  v_dot2_f32_bf16 v19, v77, s68, v19
  v_dot2_f32_bf16 v20, v78, s69, v20
  v_dot2_f32_bf16 v21, v78, s68, v21
  v_dot2_f32_bf16 v22, v79, s69, v22
  v_dot2_f32_bf16 v23, v79, s68, v23
  v_readlane_b32 s66, v10, 12
  s_waitcnt vmcnt(5)
  s_lshr_b32 s67, s66, 16
  s_nop 0
  v_dot2_f32_bf16 v16, v80, s67, v16
  v_dot2_f32_bf16 v17, v80, s66, v17
  v_dot2_f32_bf16 v18, v81, s67, v18
  v_dot2_f32_bf16 v19, v81, s66, v19
  v_dot2_f32_bf16 v20, v82, s67, v20
  v_dot2_f32_bf16 v21, v82, s66, v21
  v_dot2_f32_bf16 v22, v83, s67, v22
  v_dot2_f32_bf16 v23, v83, s66, v23
  v_readlane_b32 s68, v10, 13
  s_waitcnt vmcnt(4)
  s_lshr_b32 s69, s68, 16
  s_nop 0
  v_dot2_f32_bf16 v16, v84, s69, v16
  v_dot2_f32_bf16 v17, v84, s68, v17
  v_dot2_f32_bf16 v18, v85, s69, v18
  v_dot2_f32_bf16 v19, v85, s68, v19
  v_dot2_f32_bf16 v20, v86, s69, v20
  v_dot2_f32_bf16 v21, v86, s68, v21
  v_dot2_f32_bf16 v22, v87, s69, v22
  v_dot2_f32_bf16 v23, v87, s68, v23
  v_readlane_b32 s66, v10, 14
  s_waitcnt vmcnt(3)
  s_lshr_b32 s67, s66, 16
  s_nop 0
  v_dot2_f32_bf16 v16, v88, s67, v16
  v_dot2_f32_bf16 v17, v88, s66, v17
  v_dot2_f32_bf16 v18, v89, s67, v18
  v_dot2_f32_bf16 v19, v89, s66, v19
  v_dot2_f32_bf16 v20, v90, s67, v20
  v_dot2_f32_bf16 v21, v90, s66, v21
  v_dot2_f32_bf16 v22, v91, s67, v22
  v_dot2_f32_bf16 v23, v91, s66, v23
  v_readlane_b32 s68, v10, 15
  s_waitcnt vmcnt(2)
  s_lshr_b32 s69, s68, 16
  s_nop 0
  v_dot2_f32_bf16 v16, v92, s69, v16
  v_dot2_f32_bf16 v17, v92, s68, v17
  v_dot2_f32_bf16 v18, v93, s69, v18
  v_dot2_f32_bf16 v19, v93, s68, v19
  v_dot2_f32_bf16 v20, v94, s69, v20
  v_dot2_f32_bf16 v21, v94, s68, v21
  v_dot2_f32_bf16 v22, v95, s69, v22
  v_dot2_f32_bf16 v23, v95, s68, v23
  v_readlane_b32 s66, v10, 16
  s_waitcnt vmcnt(1)
  s_lshr_b32 s67, s66, 16
  s_nop 0
  v_dot2_f32_bf16 v16, v96, s67, v16
  v_dot2_f32_bf16 v17, v96, s66, v17
  v_dot2_f32_bf16 v18, v97, s67, v18
  v_dot2_f32_bf16 v19, v97, s66, v19
  v_dot2_f32_bf16 v20, v98, s67, v20
  v_dot2_f32_bf16 v21, v98, s66, v21
  v_dot2_f32_bf16 v22, v99, s67, v22
  v_dot2_f32_bf16 v23, v99, s66, v23
  v_readlane_b32 s68, v10, 17
  s_waitcnt vmcnt(0)
  s_lshr_b32 s69, s68, 16
  s_nop 0
  v_dot2_f32_bf16 v16, v100, s69, v16
  v_dot2_f32_bf16 v17, v100, s68, v17
  v_dot2_f32_bf16 v18, v101, s69, v18
  v_dot2_f32_bf16 v19, v101, s68, v19
  v_dot2_f32_bf16 v20, v102, s69, v20
  v_dot2_f32_bf16 v21, v102, s68, v21
  v_dot2_f32_bf16 v22, v103, s69, v22
  v_dot2_f32_bf16 v23, v103, s68, v23
  v_permlane32_swap_b32 v24, v28
  v_permlane32_swap_b32 v25, v29
  v_permlane32_swap_b32 v26, v30
  v_permlane32_swap_b32 v27, v31
  s_nop 1
  v_add_f32 v24, v24, v28
  v_add_f32 v25, v25, v29
  v_add_f32 v26, v26, v30
  v_add_f32 v27, v27, v31
  s_nop 1
  v_permlane16_swap_b32 v24, v26
  v_permlane16_swap_b32 v25, v27
  s_nop 1
  v_add_f32 v24, v24, v26
  v_add_f32 v25, v25, v27
  s_nop 0
  v_add_f32_dpp v24, v24, v24 row_ror:8 row_mask:0xf bank_mask:0xf
  v_add_f32_dpp v25, v25, v25 row_ror:8 row_mask:0xf bank_mask:0xf
  v_min_u32 v128, 0xfffffffe, v16
  v_min_u32 v129, 0xfffffffe, v17
  v_min_u32 v130, 0xfffffffe, v18
  v_min_u32 v131, 0xfffffffe, v19
  v_min_u32 v132, 0xfffffffe, v20
  v_min_u32 v133, 0xfffffffe, v21
  v_min_u32 v134, 0xfffffffe, v22
  v_min_u32 v135, 0xfffffffe, v23
  v_min_u32 v136, 0xfffffffe, v24
  v_min_u32 v137, 0xfffffffe, v25
  s_cmp_lt_u32 s30, 7
  s_cbranch_scc1 L_s_wait
L_nodown:
  s_cmp_lt_u32 s30, 7
  s_cbranch_scc1 L_end
  s_sub_u32 s58, s28, 4
  s_sub_u32 s59, s30, 7
  v_lshlrev_b32 v6, 2, v1
  v_lshrrev_b32 v4, 3, v1
  v_mul_u32_u24 v4, 1152, v4
  v_and_b32 v7, 7, v1
  v_lshl_add_u32 v4, v7, 4, v4
  s_lshl_b32 s62, s29, 2
  s_add_u32 s62, s62, s58
  s_mul_i32 s62, s62, 73728
  s_lshl_b32 s31, s59, 7
  s_add_u32 s62, s62, s31
  s_lshl_b32 s31, s58, 13
  s_add_u32 s31, s31, 50176
  v_lshlrev_b32 v7, 4, v1
  v_add_u32 v7, s31, v7
  v_lshlrev_b32 v8, 10, v3
  v_lshl_add_u32 v8, v2, 1, v8
  s_lshl_b32 s31, s58, 5
  s_add_u32 s31, s31, 50176
  v_add_u32 v8, s31, v8
  s_mov_b32 s44, s26
  s_mov_b32 s45, s27
  s_mov_b32 s46, 8388608
  s_mov_b32 s47, 0x00020000
  s_mov_b32 s36, s12
  s_mov_b32 s37, s13
  s_mov_b32 s38, 4718592
  s_mov_b32 s39, 0x00020000
  buffer_load_dwordx4 v[64:67], v4, s[36:39], s62 offen nt
  s_add_u32 s62, s62, 9216
  buffer_load_dwordx4 v[68:71], v4, s[36:39], s62 offen nt
  s_add_u32 s62, s62, 9216
  buffer_load_dwordx4 v[72:75], v4, s[36:39], s62 offen nt
  s_add_u32 s62, s62, 9216
  buffer_load_dwordx4 v[76:79], v4, s[36:39], s62 offen nt
  s_add_u32 s62, s62, 9216
  buffer_load_dwordx4 v[80:83], v4, s[36:39], s62 offen nt
  s_add_u32 s62, s62, 9216
  buffer_load_dwordx4 v[84:87], v4, s[36:39], s62 offen nt
  s_add_u32 s62, s62, 9216
  buffer_load_dwordx4 v[88:91], v4, s[36:39], s62 offen nt
  s_add_u32 s62, s62, 9216
  buffer_load_dwordx4 v[92:95], v4, s[36:39], s62 offen nt
  s_add_u32 s62, s62, 9216
  s_waitcnt vmcnt(7)
  ds_write_b128 v7, v[64:67] offset:0
  s_waitcnt vmcnt(6)
  ds_write_b128 v7, v[68:71] offset:1024
  s_waitcnt vmcnt(5)
  ds_write_b128 v7, v[72:75] offset:2048
  s_waitcnt vmcnt(4)
  ds_write_b128 v7, v[76:79] offset:3072
  s_waitcnt vmcnt(3)
  ds_write_b128 v7, v[80:83] offset:4096
  s_waitcnt vmcnt(2)
  ds_write_b128 v7, v[84:87] offset:5120
  s_waitcnt vmcnt(1)
  ds_write_b128 v7, v[88:91] offset:6144
  s_waitcnt vmcnt(0)
  ds_write_b128 v7, v[92:95] offset:7168
  v_mov_b32 v16, 0
  v_mov_b32 v17, 1
  s_waitcnt lgkmcnt(0)
  s_mov_b64 exec, 1
  ds_add_u32 v16, v17 offset:32960
  s_mov_b64 exec, -1
  s_mov_b32 s73, 0
L_wspin:
  ds_read_b32 v17, v16 offset:32960
  s_add_u32 s73, s73, 1
  s_waitcnt lgkmcnt(0)
  v_readfirstlane_b32 s31, v17
  s_cmp_ge_u32 s73, 524288
  s_cbranch_scc1 L_wspin_done
  s_cmp_ge_u32 s31, 4
  s_cbranch_scc1 L_wspin_done
  s_sleep 8
  s_branch L_wspin
L_wspin_done:
  ds_read_u16 v64, v8 offset:0
  ds_read_u16 v65, v8 offset:128
  ds_read_u16 v66, v8 offset:256
  ds_read_u16 v67, v8 offset:384
  ds_read_u16 v68, v8 offset:512
  ds_read_u16 v69, v8 offset:640
  ds_read_u16 v70, v8 offset:768
  ds_read_u16 v71, v8 offset:896
  s_waitcnt lgkmcnt(0)
  v_lshl_or_b32 v96, v65, 16, v64
  v_lshl_or_b32 v97, v67, 16, v66
  v_lshl_or_b32 v98, v69, 16, v68
  v_lshl_or_b32 v99, v71, 16, v70
  ds_read_u16 v64, v8 offset:4096
  ds_read_u16 v65, v8 offset:4224
  ds_read_u16 v66, v8 offset:4352
  ds_read_u16 v67, v8 offset:4480
  ds_read_u16 v68, v8 offset:4608
  ds_read_u16 v69, v8 offset:4736
  ds_read_u16 v70, v8 offset:4864
  ds_read_u16 v71, v8 offset:4992
  s_waitcnt lgkmcnt(0)
  v_lshl_or_b32 v100, v65, 16, v64
  v_lshl_or_b32 v101, v67, 16, v66
  v_lshl_or_b32 v102, v69, 16, v68
  v_lshl_or_b32 v103, v71, 16, v70
  ds_read_u16 v64, v8 offset:8192
  ds_read_u16 v65, v8 offset:8320
  ds_read_u16 v66, v8 offset:8448
  ds_read_u16 v67, v8 offset:8576
  ds_read_u16 v68, v8 offset:8704
  ds_read_u16 v69, v8 offset:8832
  ds_read_u16 v70, v8 offset:8960
  ds_read_u16 v71, v8 offset:9088
  s_waitcnt lgkmcnt(0)
  v_lshl_or_b32 v104, v65, 16, v64
  v_lshl_or_b32 v105, v67, 16, v66
  v_lshl_or_b32 v106, v69, 16, v68
  v_lshl_or_b32 v107, v71, 16, v70
  ds_read_u16 v64, v8 offset:12288
  ds_read_u16 v65, v8 offset:12416
  ds_read_u16 v66, v8 offset:12544
  ds_read_u16 v67, v8 offset:12672
  ds_read_u16 v68, v8 offset:12800
  ds_read_u16 v69, v8 offset:12928
  ds_read_u16 v70, v8 offset:13056
  ds_read_u16 v71, v8 offset:13184
  s_waitcnt lgkmcnt(0)
  v_lshl_or_b32 v108, v65, 16, v64
  v_lshl_or_b32 v109, v67, 16, v66
  v_lshl_or_b32 v110, v69, 16, v68
  v_lshl_or_b32 v111, v71, 16, v70
  ds_read_u16 v64, v8 offset:16384
  ds_read_u16 v65, v8 offset:16512
  ds_read_u16 v66, v8 offset:16640
  ds_read_u16 v67, v8 offset:16768
  ds_read_u16 v68, v8 offset:16896
  ds_read_u16 v69, v8 offset:17024
  ds_read_u16 v70, v8 offset:17152
  ds_read_u16 v71, v8 offset:17280
  s_waitcnt lgkmcnt(0)
  v_lshl_or_b32 v112, v65, 16, v64
  v_lshl_or_b32 v113, v67, 16, v66
  v_lshl_or_b32 v114, v69, 16, v68
  v_lshl_or_b32 v115, v71, 16, v70
  ds_read_u16 v64, v8 offset:20480
  ds_read_u16 v65, v8 offset:20608
  ds_read_u16 v66, v8 offset:20736
  ds_read_u16 v67, v8 offset:20864
  ds_read_u16 v68, v8 offset:20992
  ds_read_u16 v69, v8 offset:21120
  ds_read_u16 v70, v8 offset:21248
  ds_read_u16 v71, v8 offset:21376
  s_waitcnt lgkmcnt(0)
  v_lshl_or_b32 v116, v65, 16, v64
  v_lshl_or_b32 v117, v67, 16, v66
  v_lshl_or_b32 v118, v69, 16, v68
  v_lshl_or_b32 v119, v71, 16, v70
  ds_read_u16 v64, v8 offset:24576
  ds_read_u16 v65, v8 offset:24704
  ds_read_u16 v66, v8 offset:24832
  ds_read_u16 v67, v8 offset:24960
  ds_read_u16 v68, v8 offset:25088
  ds_read_u16 v69, v8 offset:25216
  ds_read_u16 v70, v8 offset:25344
  ds_read_u16 v71, v8 offset:25472
  s_waitcnt lgkmcnt(0)
  v_lshl_or_b32 v120, v65, 16, v64
  v_lshl_or_b32 v121, v67, 16, v66
  v_lshl_or_b32 v122, v69, 16, v68
  v_lshl_or_b32 v123, v71, 16, v70
  ds_read_u16 v64, v8 offset:28672
  ds_read_u16 v65, v8 offset:28800
  ds_read_u16 v66, v8 offset:28928
  ds_read_u16 v67, v8 offset:29056
  ds_read_u16 v68, v8 offset:29184
  ds_read_u16 v69, v8 offset:29312
  ds_read_u16 v70, v8 offset:29440
  ds_read_u16 v71, v8 offset:29568
  s_waitcnt lgkmcnt(0)
  v_lshl_or_b32 v124, v65, 16, v64
  v_lshl_or_b32 v125, v67, 16, v66
  v_lshl_or_b32 v126, v69, 16, v68
  v_lshl_or_b32 v127, v71, 16, v70
  s_cmp_lg_u32 s58, 0
  s_cbranch_scc1 L_s_wait
  s_cmp_lg_u32 s29, s59
  s_cbranch_scc1 L_s_wait
  s_mov_b32 s32, s4
  s_mov_b32 s33, s5
  s_mov_b32 s34, 1152
  s_mov_b32 s35, 0x00020000
  s_lshl_b32 s31, s59, 7
  v_lshlrev_b32 v13, 1, v1
  buffer_load_ushort v15, v13, s[32:35], s31 offen
  s_waitcnt vmcnt(0)
  v_lshlrev_b32 v15, 16, v15
L_s_wait:
  s_barrier
L_tail:
  v_lshlrev_b32 v5, 4, v1
  s_lshl_b32 s62, s29, 15
  s_cmp_lg_u32 s28, 7
  s_cbranch_scc1 L_nofs
  s_mul_i32 s65, s2, 2304
  s_add_u32 s65, s65, 1835008
  buffer_store_dwordx4 v[128:131], v5, s[44:47], s65 offen sc1
  buffer_store_dwordx4 v[132:135], v5, s[44:47], s65 offen offset:1024 sc1
  v_and_b32 v10, 7, v1
  v_lshlrev_b32 v10, 5, v10
  v_lshl_add_u32 v10, v3, 3, v10
  buffer_store_dwordx2 v[136:137], v10, s[44:47], s65 offen offset:2048 sc1
L_nofs:
  s_cmp_lg_u32 s28, 3
  s_cbranch_scc1 L_poll
  v_lshrrev_b32 v10, 5, v1
  v_lshlrev_b32 v10, 2, v10
  ds_read_b128 v[16:19], v5 offset:0
  ds_read_b128 v[20:23], v5 offset:8192
  ds_read_b128 v[24:27], v5 offset:16384
  ds_read_b128 v[28:31], v5 offset:24576
  ds_read_b32 v32, v10 offset:32768
  ds_read_b32 v33, v10 offset:32776
  ds_read_b32 v34, v10 offset:32784
  ds_read_b32 v35, v10 offset:32792
  ds_read_b32 v36, v10 offset:32800
  ds_read_b32 v37, v10 offset:32808
  ds_read_b32 v38, v10 offset:32816
  ds_read_b32 v39, v10 offset:32824
  s_lshl_b32 s63, s2, 11
  s_waitcnt lgkmcnt(0)
  v_max_f32 v11, v32, v34
  v_max3_f32 v11, v11, v36, v38
  v_sub_f32 v32, v32, v11
  v_mul_f32 v32, s56, v32
  v_exp_f32 v32, v32
  v_sub_f32 v34, v34, v11
  v_mul_f32 v34, s56, v34
  v_exp_f32 v34, v34
  v_sub_f32 v36, v36, v11
  v_mul_f32 v36, s56, v36
  v_exp_f32 v36, v36
  v_sub_f32 v38, v38, v11
  v_mul_f32 v38, s56, v38
  v_exp_f32 v38, v38
  s_nop 0
  v_mul_f32 v12, v32, v33
  v_fmac_f32 v12, v34, v35
  v_fmac_f32 v12, v36, v37
  v_fmac_f32 v12, v38, v39
  v_mul_f32 v40, v32, v16
  v_fmac_f32 v40, v34, v20
  v_fmac_f32 v40, v36, v24
  v_fmac_f32 v40, v38, v28
  v_mul_f32 v41, v32, v17
  v_fmac_f32 v41, v34, v21
  v_fmac_f32 v41, v36, v25
  v_fmac_f32 v41, v38, v29
  v_mul_f32 v42, v32, v18
  v_fmac_f32 v42, v34, v22
  v_fmac_f32 v42, v36, v26
  v_fmac_f32 v42, v38, v30
  v_mul_f32 v43, v32, v19
  v_fmac_f32 v43, v34, v23
  v_fmac_f32 v43, v36, v27
  v_fmac_f32 v43, v38, v31
  v_min_u32 v40, 0xfffffffe, v40
  v_min_u32 v41, 0xfffffffe, v41
  v_min_u32 v42, 0xfffffffe, v42
  v_min_u32 v43, 0xfffffffe, v43
  buffer_store_dwordx4 v[40:43], v5, s[44:47], s63 offen sc1
  v_min_u32 v12, 0xfffffffe, v12
  v_min_u32 v11, 0xfffffffe, v11
  s_mov_b32 exec_lo, 1
  s_mov_b32 exec_hi, 1
  buffer_store_dword v11, v10, s[44:47], s63 offen offset:1024 sc1
  buffer_store_dword v12, v10, s[44:47], s63 offen offset:1032 sc1
  s_mov_b64 exec, -1
L_poll:
  s_cmp_lt_u32 s30, 7
  s_cbranch_scc1 L_end
  s_lshl_b32 s31, s28, 12
  s_add_u32 s62, s62, s31
  v_mov_b32 v10, 0
  s_mov_b32 s72, 0
  s_sub_u32 s59, s30, 7
  v_bfe_u32 v8, v1, 2, 1
  v_lshlrev_b32 v8, 10, v8
  v_lshrrev_b32 v9, 3, v1
  v_lshl_add_u32 v8, v9, 4, v8
  v_and_b32 v9, 3, v1
  v_lshl_add_u32 v8, v9, 2, v8
  v_lshlrev_b32 v9, 2, v1
  s_lshl_b32 s31, s59, 7
  s_cmp_eq_u32 s59, 8
  s_cselect_b32 s31, 2048, s31
  s_cselect_b64 vcc, -1, 0
  v_cndmask_b32 v8, v8, v9, vcc
  s_lshl_b32 s65, s29, 3
  s_add_u32 s65, s65, s28
  s_mul_i32 s65, s65, 4608
  s_add_u32 s65, s65, s31
  s_add_u32 s65, s65, 1835008
L_poll_loop:
  buffer_load_dword v32, v8, s[44:47], s65 offen sc1
  buffer_load_dword v33, v8, s[44:47], s65 offen offset:2304 sc1
  buffer_load_dwordx4 v[16:19], v5, s[44:47], s62 offen sc1
  buffer_load_dwordx4 v[20:23], v5, s[44:47], s62 offen offset:2048 sc1
  buffer_load_dwordx4 v[24:27], v10, s[44:47], s62 offen offset:1024 sc1
  buffer_load_dwordx4 v[28:31], v10, s[44:47], s62 offen offset:3072 sc1
  s_add_u32 s72, s72, 1
  s_waitcnt vmcnt(0)
  v_max3_u32 v11, v16, v17, v18
  v_max3_u32 v12, v19, v20, v21
  v_max3_u32 v13, v22, v23, v24
  v_max3_u32 v11, v11, v25, v26
  v_max3_u32 v12, v12, v27, v28
  v_max3_u32 v13, v13, v29, v30
  v_max3_u32 v11, v11, v12, v13
  v_max3_u32 v11, v11, v31, v32
  v_max_u32 v11, v11, v33
  v_cmp_eq_u32 vcc, -1, v11
  s_cmp_ge_u32 s72, 65536
  s_cbranch_scc1 L_poll_done
  s_cbranch_vccz L_poll_done
  s_sleep 4
  s_branch L_poll_loop
L_poll_done:
  s_lshl_b32 s31, s28, 11
  v_add_u32 v11, s31, v5
  ds_write_b128 v11, v[16:19] offset:33280
  ds_write_b128 v11, v[20:23] offset:34304
  v_add_f32 v32, v32, v33
  s_lshl_b32 s31, s28, 8
  s_add_u32 s31, s31, 82944
  v_add_u32 v11, s31, v9
  ds_write_b32 v11, v32
  s_lshl_b32 s31, s28, 5
  v_mov_b32 v11, s31
  s_mov_b64 exec, 1
  ds_write_b128 v11, v[24:27] offset:33024
  ds_write_b128 v11, v[28:31] offset:33040
  s_mov_b64 exec, -1
  s_waitcnt lgkmcnt(0)
  s_barrier
  s_cmp_ge_u32 s28, 4
  s_cbranch_scc1 L_tail_s
  s_lshr_b32 s31, s28, 1
  s_lshl_b32 s31, s31, 2
  v_lshlrev_b32 v10, 4, v2
  v_add_u32 v10, s31, v10
  ds_read_b32 v12, v10 offset:33024
  ds_read_b32 v13, v10 offset:33032
  v_lshlrev_b32 v11, 2, v0
  ds_read_b32 v16, v11 offset:33280
  ds_read_b32 v17, v11 offset:34304
  ds_read_b32 v18, v11 offset:35328
  ds_read_b32 v19, v11 offset:36352
  ds_read_b32 v20, v11 offset:37376
  ds_read_b32 v21, v11 offset:38400
  ds_read_b32 v22, v11 offset:39424
  ds_read_b32 v23, v11 offset:40448
  ds_read_b32 v24, v11 offset:41472
  ds_read_b32 v25, v11 offset:42496
  ds_read_b32 v26, v11 offset:43520
  ds_read_b32 v27, v11 offset:44544
  ds_read_b32 v28, v11 offset:45568
  ds_read_b32 v29, v11 offset:46592
  ds_read_b32 v30, v11 offset:47616
  ds_read_b32 v31, v11 offset:48640
  s_waitcnt lgkmcnt(0)
  v_max_f32_dpp v14, v12, v12 row_ror:1 row_mask:0xf bank_mask:0xf
  s_nop 1
  v_max_f32_dpp v14, v14, v14 row_ror:2 row_mask:0xf bank_mask:0xf
  s_nop 1
  v_max_f32_dpp v14, v14, v14 row_ror:4 row_mask:0xf bank_mask:0xf
  s_nop 1
  v_max_f32_dpp v14, v14, v14 row_ror:8 row_mask:0xf bank_mask:0xf
  v_sub_f32 v12, v12, v14
  v_mul_f32 v12, s56, v12
  v_exp_f32 v12, v12
  s_nop 0
  v_mul_f32 v13, v12, v13
  s_nop 1
  v_add_f32_dpp v13, v13, v13 row_ror:1 row_mask:0xf bank_mask:0xf
  s_nop 1
  v_add_f32_dpp v13, v13, v13 row_ror:2 row_mask:0xf bank_mask:0xf
  s_nop 1
  v_add_f32_dpp v13, v13, v13 row_ror:4 row_mask:0xf bank_mask:0xf
  s_nop 1
  v_add_f32_dpp v13, v13, v13 row_ror:8 row_mask:0xf bank_mask:0xf
  v_rcp_f32 v15, v13
  v_mul_f32_dpp v32, v12, v16 row_newbcast:0 row_mask:0xf bank_mask:0xf
  v_mul_f32_dpp v33, v12, v17 row_newbcast:1 row_mask:0xf bank_mask:0xf
  v_mul_f32_dpp v34, v12, v18 row_newbcast:2 row_mask:0xf bank_mask:0xf
  v_mul_f32_dpp v35, v12, v19 row_newbcast:3 row_mask:0xf bank_mask:0xf
  v_fmac_f32_dpp v32, v12, v20 row_newbcast:4 row_mask:0xf bank_mask:0xf
  v_fmac_f32_dpp v33, v12, v21 row_newbcast:5 row_mask:0xf bank_mask:0xf
  v_fmac_f32_dpp v34, v12, v22 row_newbcast:6 row_mask:0xf bank_mask:0xf
  v_fmac_f32_dpp v35, v12, v23 row_newbcast:7 row_mask:0xf bank_mask:0xf
  v_fmac_f32_dpp v32, v12, v24 row_newbcast:8 row_mask:0xf bank_mask:0xf
  v_fmac_f32_dpp v33, v12, v25 row_newbcast:9 row_mask:0xf bank_mask:0xf
  v_fmac_f32_dpp v34, v12, v26 row_newbcast:10 row_mask:0xf bank_mask:0xf
  v_fmac_f32_dpp v35, v12, v27 row_newbcast:11 row_mask:0xf bank_mask:0xf
  v_fmac_f32_dpp v32, v12, v28 row_newbcast:12 row_mask:0xf bank_mask:0xf
  v_fmac_f32_dpp v33, v12, v29 row_newbcast:13 row_mask:0xf bank_mask:0xf
  v_fmac_f32_dpp v34, v12, v30 row_newbcast:14 row_mask:0xf bank_mask:0xf
  v_fmac_f32_dpp v35, v12, v31 row_newbcast:15 row_mask:0xf bank_mask:0xf
  v_add_f32 v32, v32, v33
  v_add_f32 v34, v34, v35
  v_add_f32 v14, v32, v34
  v_mul_f32 v16, v14, v15
  v_fma_f32 v17, -v16, v13, v14
  v_fma_f32 v16, v17, v15, v16
  v_cvt_pk_bf16_f32 v16, v16, v16
  v_lshlrev_b32 v11, 1, v0
  ds_write_b16 v11, v16 offset:49664
  s_waitcnt lgkmcnt(0)
  s_barrier
  s_endpgm
L_tail_s:
  v_lshlrev_b32 v10, 4, v3
  s_lshl_b32 s63, s59, 4
  s_add_u32 s63, s63, s29
  s_lshl_b32 s63, s63, 8
  s_add_u32 s63, s63, 1048576
  s_lshl_b32 s31, s58, 6
  s_add_u32 s63, s63, s31
  v_lshlrev_b32 v11, 2, v1
  s_cmp_lg_u32 s58, 1
  s_cbranch_scc1 L_nof2
  v_add_u32 v12, 82944, v11
  ds_read_b32 v16, v12 offset:0
  ds_read_b32 v17, v12 offset:256
  ds_read_b32 v18, v12 offset:512
  ds_read_b32 v19, v12 offset:768
  ds_read_b32 v20, v12 offset:1024
  ds_read_b32 v21, v12 offset:1280
  ds_read_b32 v22, v12 offset:1536
  ds_read_b32 v23, v12 offset:1792
  s_add_u32 s31, s63, 131008
  s_waitcnt lgkmcnt(0)
  v_add_f32 v16, v16, v20
  v_add_f32 v17, v17, v21
  v_add_f32 v18, v18, v22
  v_add_f32 v19, v19, v23
  v_add_f32 v16, v16, v18
  v_add_f32 v17, v17, v19
  v_add_f32 v16, v16, v17
  v_min_u32 v16, 0xfffffffe, v16
  buffer_store_dword v16, v11, s[44:47], s31 offen sc1
L_nof2:
  s_barrier
  ds_read_b128 v[16:19], v10 offset:49664
  ds_read_b128 v[20:23], v10 offset:49728
  ds_read_b128 v[24:27], v10 offset:49792
  ds_read_b128 v[28:31], v10 offset:49856
  ds_read_b128 v[32:35], v10 offset:49920
  ds_read_b128 v[36:39], v10 offset:49984
  ds_read_b128 v[40:43], v10 offset:50048
  ds_read_b128 v[44:47], v10 offset:50112
  s_waitcnt lgkmcnt(7)
  v_mfma_f32_16x16x32_bf16 v[48:51], v[16:19], v[96:99], 0
  s_waitcnt lgkmcnt(6)
  v_mfma_f32_16x16x32_bf16 v[48:51], v[20:23], v[100:103], v[48:51]
  s_waitcnt lgkmcnt(5)
  v_mfma_f32_16x16x32_bf16 v[48:51], v[24:27], v[104:107], v[48:51]
  s_waitcnt lgkmcnt(4)
  v_mfma_f32_16x16x32_bf16 v[48:51], v[28:31], v[108:111], v[48:51]
  s_waitcnt lgkmcnt(3)
  v_mfma_f32_16x16x32_bf16 v[48:51], v[32:35], v[112:115], v[48:51]
  s_waitcnt lgkmcnt(2)
  v_mfma_f32_16x16x32_bf16 v[48:51], v[36:39], v[116:119], v[48:51]
  s_waitcnt lgkmcnt(1)
  v_mfma_f32_16x16x32_bf16 v[48:51], v[40:43], v[120:123], v[48:51]
  s_waitcnt lgkmcnt(0)
  v_mfma_f32_16x16x32_bf16 v[48:51], v[44:47], v[124:127], v[48:51]
  s_mov_b64 exec, 0xffff
  s_nop 7
  v_min_u32 v48, 0xfffffffe, v48
  buffer_store_dword v48, v11, s[44:47], s63 offen sc1
  s_mov_b64 exec, -1
  s_cmp_lg_u32 s58, 0
  s_cbranch_scc1 L_end
  s_cmp_lg_u32 s29, s59
  s_cbranch_scc1 L_end
  s_lshl_b32 s63, s59, 12
  s_add_u32 s63, s63, 1048576
  s_mov_b32 s40, s22
  s_mov_b32 s41, s23
  s_mov_b32 s42, 1152
  s_mov_b32 s43, 0x00020000
  s_mov_b32 s72, 0
  s_add_u32 s65, s63, 131072
L_fin_loop:
  buffer_load_dword v64, v11, s[44:47], s65 offen offset:0 sc1
  buffer_load_dword v65, v11, s[44:47], s65 offen offset:256 sc1
  buffer_load_dword v66, v11, s[44:47], s65 offen offset:512 sc1
  buffer_load_dword v67, v11, s[44:47], s65 offen offset:768 sc1
  buffer_load_dword v68, v11, s[44:47], s65 offen offset:1024 sc1
  buffer_load_dword v69, v11, s[44:47], s65 offen offset:1280 sc1
  buffer_load_dword v70, v11, s[44:47], s65 offen offset:1536 sc1
  buffer_load_dword v71, v11, s[44:47], s65 offen offset:1792 sc1
  buffer_load_dword v72, v11, s[44:47], s65 offen offset:2048 sc1
  buffer_load_dword v73, v11, s[44:47], s65 offen offset:2304 sc1
  buffer_load_dword v74, v11, s[44:47], s65 offen offset:2560 sc1
  buffer_load_dword v75, v11, s[44:47], s65 offen offset:2816 sc1
  buffer_load_dword v76, v11, s[44:47], s65 offen offset:3072 sc1
  buffer_load_dword v77, v11, s[44:47], s65 offen offset:3328 sc1
  buffer_load_dword v78, v11, s[44:47], s65 offen offset:3584 sc1
  buffer_load_dword v79, v11, s[44:47], s65 offen offset:3840 sc1
  buffer_load_dword v16, v11, s[44:47], s63 offen offset:0 sc1
  buffer_load_dword v17, v11, s[44:47], s63 offen offset:256 sc1
  buffer_load_dword v18, v11, s[44:47], s63 offen offset:512 sc1
  buffer_load_dword v19, v11, s[44:47], s63 offen offset:768 sc1
  buffer_load_dword v20, v11, s[44:47], s63 offen offset:1024 sc1
  buffer_load_dword v21, v11, s[44:47], s63 offen offset:1280 sc1
  buffer_load_dword v22, v11, s[44:47], s63 offen offset:1536 sc1
  buffer_load_dword v23, v11, s[44:47], s63 offen offset:1792 sc1
  buffer_load_dword v24, v11, s[44:47], s63 offen offset:2048 sc1
  buffer_load_dword v25, v11, s[44:47], s63 offen offset:2304 sc1
  buffer_load_dword v26, v11, s[44:47], s63 offen offset:2560 sc1
  buffer_load_dword v27, v11, s[44:47], s63 offen offset:2816 sc1
  buffer_load_dword v28, v11, s[44:47], s63 offen offset:3072 sc1
  buffer_load_dword v29, v11, s[44:47], s63 offen offset:3328 sc1
  buffer_load_dword v30, v11, s[44:47], s63 offen offset:3584 sc1
  buffer_load_dword v31, v11, s[44:47], s63 offen offset:3840 sc1
  s_add_u32 s72, s72, 1
  s_waitcnt vmcnt(16)
  v_max3_u32 v35, v64, v65, v66
  v_max3_u32 v36, v67, v68, v69
  v_max3_u32 v37, v70, v71, v72
  v_max3_u32 v35, v35, v73, v74
  v_max3_u32 v36, v36, v75, v76
  v_max3_u32 v37, v37, v77, v78
  v_max3_u32 v35, v35, v36, v37
  v_max_u32 v35, v35, v79
  v_add_f32 v64, v64, v72
  v_add_f32 v65, v65, v73
  v_add_f32 v66, v66, v74
  v_add_f32 v67, v67, v75
  v_add_f32 v68, v68, v76
  v_add_f32 v69, v69, v77
  v_add_f32 v70, v70, v78
  v_add_f32 v71, v71, v79
  v_add_f32 v64, v64, v68
  v_add_f32 v65, v65, v69
  v_add_f32 v66, v66, v70
  v_add_f32 v67, v67, v71
  v_add_f32 v64, v64, v66
  v_add_f32 v65, v65, v67
  v_add_f32 v64, v64, v65
  v_cvt_pk_bf16_f32 v64, v64, v64
  v_lshlrev_b32 v64, 16, v64
  v_mul_f32 v65, 0xbfb8aa3b, v64
  v_exp_f32 v65, v65
  s_nop 0
  v_add_f32 v65, 1.0, v65
  v_rcp_f32 v65, v65
  s_nop 0
  v_mul_f32 v64, v64, v65
  v_cvt_pk_bf16_f32 v14, v64, v64
  v_lshlrev_b32 v14, 16, v14
  s_waitcnt vmcnt(0)
  v_max3_u32 v32, v16, v17, v18
  v_max3_u32 v33, v19, v20, v21
  v_max3_u32 v34, v22, v23, v24
  v_max3_u32 v32, v32, v25, v26
  v_max3_u32 v33, v33, v27, v28
  v_max3_u32 v34, v34, v29, v30
  v_max3_u32 v32, v32, v33, v34
  v_max3_u32 v32, v32, v31, v35
  v_cmp_eq_u32 vcc, -1, v32
  s_cmp_ge_u32 s72, 65536
  s_cbranch_scc1 L_fin_done
  s_cbranch_vccz L_fin_done
  s_sleep 1
  s_branch L_fin_loop
L_fin_done:
  v_add_f32 v16, v16, v24
  v_add_f32 v17, v17, v25
  v_add_f32 v18, v18, v26
  v_add_f32 v19, v19, v27
  v_add_f32 v20, v20, v28
  v_add_f32 v21, v21, v29
  v_add_f32 v22, v22, v30
  v_add_f32 v23, v23, v31
  v_add_f32 v16, v16, v20
  v_add_f32 v17, v17, v21
  v_add_f32 v18, v18, v22
  v_add_f32 v19, v19, v23
  v_add_f32 v16, v16, v18
  v_add_f32 v17, v17, v19
  v_add_f32 v16, v16, v17
  v_cvt_pk_bf16_f32 v16, v16, v16
  v_lshlrev_b32 v16, 16, v16
  v_mul_f32 v16, v16, v14
  v_cvt_pk_bf16_f32 v16, v16, v16
  v_lshlrev_b32 v16, 16, v16
  v_add_f32 v16, v16, v15
  v_cvt_pk_bf16_f32 v16, v16, v16
  v_lshlrev_b32 v11, 1, v1
  s_lshl_b32 s31, s59, 7
  buffer_store_short v16, v11, s[40:43], s31 offen
L_end:
L_end2:
  s_endpgm
.section .rodata,"a"
.p2align 6
.amdhsa_kernel pre_kernel
  .amdhsa_next_free_vgpr 128
  .amdhsa_next_free_sgpr 102
  .amdhsa_accum_offset 128
  .amdhsa_group_segment_fixed_size 0
  .amdhsa_kernarg_size 96
  .amdhsa_user_sgpr_count 2
  .amdhsa_user_sgpr_kernarg_segment_ptr 1
  .amdhsa_system_sgpr_workgroup_id_x 1
  .amdhsa_float_denorm_mode_32 3
.end_amdhsa_kernel
.p2align 6
.amdhsa_kernel recurrent_scan__gqa_block_cached__geglu_ffn__decode_kernel
  .amdhsa_next_free_vgpr 144
  .amdhsa_next_free_sgpr 102
  .amdhsa_accum_offset 144
  .amdhsa_group_segment_fixed_size 0
  .amdhsa_kernarg_size 96
  .amdhsa_user_sgpr_count 2
  .amdhsa_user_sgpr_kernarg_segment_ptr 1
  .amdhsa_system_sgpr_workgroup_id_x 1
  .amdhsa_float_denorm_mode_32 3
.end_amdhsa_kernel
```
